```python
import torch

def _softmax(x, axis=-1):
    return torch.softmax(x, dim=axis)
def _gelu(x):
    return torch.nn.functional.gelu(x, approximate="tanh")
def _silu(x):
    return torch.nn.functional.silu(x)
def _sigmoid(x):
    return torch.sigmoid(x)
def _layernorm(x, axis=-1, eps=1e-5):
    m = x.mean(dim=axis, keepdim=True)
    v = x.var(dim=axis, keepdim=True, unbiased=False)
    return (x - m) / torch.sqrt(v + eps)
def _scatter_add(tgt, idx, src, axis=0):
    return tgt.clone().index_add_(axis, idx, src)
def _segment_sum(src, seg, n):
    out = torch.zeros((n,) + src.shape[1:], dtype=src.dtype)
    return out.index_add_(0, seg, src)
def _pad(x, pw):
    flat = tuple(v for pair in reversed(pw) for v in pair)
    return torch.nn.functional.pad(x, flat)

kernel_name = 'gated_mix__ssm_conv_h3__softmax_full_mha__prompt'

def setup_inputs():

    _w = (lambda a: (lambda t: t.to(torch.bfloat16) if t.is_floating_point() else t)(torch.as_tensor(a)))
    def _A_setup():
        B, S, D = 1, 2048, 512
        ks = 4
        return {
            "q": _w((lambda *s: torch.randn(*s, dtype=torch.bfloat16) * 0.05)(B, S, D)),
            "k": _w((lambda *s: torch.randn(*s, dtype=torch.bfloat16) * 0.4)(B, S, D)),
            "v": _w((lambda *s: torch.randn(*s, dtype=torch.bfloat16) * 0.4)(B, S, D)),
            "shift_k": _w((lambda *s: torch.randn(*s, dtype=torch.bfloat16) * 0.4)(D, ks) * 0.5),
            "ssm_k": _w((lambda *s: torch.randn(*s, dtype=torch.bfloat16) * 1.6)(D, S) * (1.0 / S ** 0.5)),
            "ssm_D": _w((lambda *s: torch.randn(*s, dtype=torch.bfloat16) * 0.4)(D)),
        }
    _A_in = _A_setup()

    def _B_setup():
        B, S, D = 1, 2048, 512
        return {
            "x": _w((lambda *s: torch.randn(*s, dtype=torch.bfloat16) * 0.05)(B, S, D)),
            "wqkv": _w((lambda *s: torch.randn(*s, dtype=torch.bfloat16) * 0.8)(D, 3 * D)),
            "wo": _w((lambda *s: torch.randn(*s, dtype=torch.bfloat16) * 0.05)(D, D)),
        }
    _B_in = _B_setup()

    return {
        "A_q": _A_in["q"],
        "A_k": _A_in["k"],
        "A_v": _A_in["v"],
        "A_shift_k": _A_in["shift_k"],
        "A_ssm_k": _A_in["ssm_k"],
        "A_ssm_D": _A_in["ssm_D"],
        "B_x": _B_in["x"],
        "B_wqkv": _B_in["wqkv"],
        "B_wo": _B_in["wo"],
        "gate_w": _w((lambda *s: torch.randn(*s, dtype=torch.bfloat16) * 0.05)(512) * 16.0),
    }

def reference(A_q, A_k, A_v, A_shift_k, A_ssm_k, A_ssm_D, B_x, B_wqkv, B_wo, gate_w):
    def _A_ref(q, k, v, shift_k, ssm_k, ssm_D):
        B, S, D = q.shape
        ks = shift_k.shape[-1]
        k_pad = _pad(k, ((0, 0), (ks - 1, 0), (0, 0)))
        k_shift = torch.zeros_like(k)
        for t in range(ks):
            k_shift = k_shift + k_pad[:, t:t + S, :] * shift_k[:, ks - 1 - t][None, None, :]
        kv = k_shift * v
        L = 2 * S
        kv_pad = _pad(kv, ((0, 0), (0, S), (0, 0)))
        kf_pad = _pad(ssm_k, ((0, 0), (0, S)))
        kv_f = (lambda x, axes=(-2,-1): torch.fft.rfft2(x.float(), dim=axes))(kv_pad[:, None, :, :], axes=(1, 2))
        kf_f = (lambda x, axes=(-2,-1): torch.fft.rfft2(x.float(), dim=axes))(kf_pad[:, None, :], axes=(1, 2))
        kf_f = (lambda x, *d: x.permute(*d))(kf_f, 1, 2, 0)
        y_f = kv_f * kf_f[None, :, :, :]
        y = (lambda x, s, axes=(-2,-1): torch.fft.irfft2(x, s=s, dim=axes).to(torch.bfloat16))(y_f, (1, L), axes=(1, 2))[:, 0, :S, :]
        y = y + kv * ssm_D[None, None, :]
        return q * y

    def _B_ref(x, wqkv, wo):
        B, S, D = x.shape
        H = 32; Dh = D // H
        qkv = (lambda x, *d: x.permute(*d))((x @ wqkv).reshape(B, S, 3, H, Dh), 2, 0, 3, 1, 4)
        q, k, v = qkv[0], qkv[1], qkv[2]
        scale = Dh ** -0.5
        scores = torch.einsum("bhqd,bhkd->bhqk", q, k) * scale
        p = _softmax(scores, axis=-1)
        o = torch.einsum("bhqk,bhkd->bhqd", p, v)
        return (lambda x, *d: x.permute(*d))(o, 0, 2, 1, 3).reshape(B, S, D) @ wo

    x = A_q
    g = _sigmoid((x * gate_w).sum(-1, keepdims=True))
    a = _A_ref(x, A_k, A_v, A_shift_k, A_ssm_k, A_ssm_D)
    b = _B_ref(x, B_wqkv, B_wo)
    return g * a + (1 - g) * b
```

```asm
; @launch kernel=k1_qkv_prep_kernel grid=(256,1,1) block=(512,1,1) lds=163840
; @launch kernel=k2_attn_conv_kernel grid=(256,1,1) block=(640,1,1) lds=161024
; @launch kernel=k3_outproj_mix_kernel grid=(256,1,1) block=(256,1,1) lds=131072
.amdgcn_target "amdgcn-amd-amdhsa--gfx950"
.text
.globl k1_qkv_prep_kernel
.p2align 8
.type k1_qkv_prep_kernel,@function
k1_qkv_prep_kernel:
    s_load_dwordx2 s[4:5], s[0:1], 0
    s_load_dwordx2 s[6:7], s[0:1], 56
    s_load_dwordx2 s[8:9], s[0:1], 96
    s_load_dwordx2 s[10:11], s[0:1], 8
    s_load_dwordx2 s[12:13], s[0:1], 16
    s_load_dwordx2 s[14:15], s[0:1], 24
    s_load_dwordx2 s[16:17], s[0:1], 72
    v_lshrrev_b32 v1, 6, v0
    s_nop 0
    v_readfirstlane_b32 s3, v1
    v_and_b32 v1, 63, v0
    s_waitcnt lgkmcnt(0)
    s_mov_b32 s20, s4
    s_and_b32 s21, s5, 0xffff
    s_mov_b32 s22, 2097152
    s_mov_b32 s23, 0x00020000
    s_mov_b32 s28, s8
    s_and_b32 s29, s9, 0xffff
    s_mov_b32 s30, 12648448
    s_mov_b32 s31, 0x00020000
    s_cmp_ge_u32 s2, 192
    s_cbranch_scc1 k1_qkv_prep_kernel_prep1
    s_mov_b32 s24, s6
    s_and_b32 s25, s7, 0xffff
    s_mov_b32 s26, 1572864
    s_mov_b32 s27, 0x00020000
    s_and_b32 s18, s2, 15
    s_lshr_b32 s19, s2, 4
    s_lshl_b32 s32, s18, 7
    s_lshl_b32 s33, s19, 7
    s_lshl_b32 s34, s32, 10
    s_lshl_b32 s35, s33, 1
    s_cmp_ge_u32 s19, 8
    s_cbranch_scc1 k1_qkv_prep_kernel_vtype3
    s_lshr_b32 s36, s3, 1
    s_and_b32 s37, s3, 1
    v_lshrrev_b32 v5, 4, v1
    v_and_b32 v5, 7, v5
    v_and_b32 v6, 7, v1
    v_xor_b32 v5, v5, v6
    v_lshlrev_b32 v5, 4, v5
    v_lshrrev_b32 v6, 3, v1
    v_lshl_add_u32 v2, v6, 10, v5
    v_lshrrev_b32 v5, 4, v1
    v_add_u32 v5, 4, v5
    v_and_b32 v5, 7, v5
    v_and_b32 v6, 7, v1
    v_xor_b32 v5, v5, v6
    v_lshlrev_b32 v5, 4, v5
    v_lshrrev_b32 v6, 3, v1
    v_lshl_add_u32 v3, v6, 10, v5
    v_lshrrev_b32 v5, 4, v1
    v_lshlrev_b32 v6, 2, v5
    v_and_b32 v4, 15, v1
    v_xor_b32 v4, v4, v6
    v_lshlrev_b32 v4, 4, v4
    s_mov_b32 s38, 3072
    v_mul_lo_u32 v5, v5, s38
    v_add_u32 v4, v4, v5
    s_mul_i32 s39, s3, 16384
    s_add_u32 s39, s39, s34
    s_mul_i32 s40, s3, 24576
    s_add_u32 s40, s40, s35
    s_lshl_b32 s41, s3, 11
    v_and_b32 v13, 31, v1
    v_lshrrev_b32 v14, 5, v1
    v_lshrrev_b32 v5, 1, v1
    v_and_b32 v5, 7, v5
    s_mul_i32 s42, s36, 4096
    s_add_u32 s42, s42, 0
    v_add_u32 v6, 0, v14
    v_xor_b32 v6, v6, v5
    v_lshlrev_b32 v6, 4, v6
    v_lshl_add_u32 v7, v13, 7, v6
    v_add_u32 v7, s42, v7
    v_add_u32 v6, 2, v14
    v_xor_b32 v6, v6, v5
    v_lshlrev_b32 v6, 4, v6
    v_lshl_add_u32 v8, v13, 7, v6
    v_add_u32 v8, s42, v8
    v_add_u32 v6, 4, v14
    v_xor_b32 v6, v6, v5
    v_lshlrev_b32 v6, 4, v6
    v_lshl_add_u32 v9, v13, 7, v6
    v_add_u32 v9, s42, v9
    v_add_u32 v6, 6, v14
    v_xor_b32 v6, v6, v5
    v_lshlrev_b32 v6, 4, v6
    v_lshl_add_u32 v10, v13, 7, v6
    v_add_u32 v10, s42, v10
    v_lshrrev_b32 v15, 4, v1
    v_and_b32 v17, 15, v1
    v_lshrrev_b32 v16, 2, v17
    v_and_b32 v17, 3, v17
    v_and_b32 v18, 1, v15
    v_lshlrev_b32 v18, 1, v18
    v_lshrrev_b32 v5, 1, v17
    v_add_u32 v18, v18, v5
    s_mul_i32 s42, s37, 2
    s_add_u32 s42, s42, 0
    v_xor_b32 v5, s42, v16
    v_lshl_add_u32 v5, v5, 2, v18
    v_lshlrev_b32 v5, 4, v5
    v_and_b32 v6, 1, v17
    v_lshl_add_u32 v5, v6, 3, v5
    v_lshrrev_b32 v6, 1, v15
    v_lshl_add_u32 v6, v6, 3, v16
    v_mul_u32_u24 v6, 256, v6
    v_add_u32 v11, v5, v6
    v_add_u32 v11, 16384, v11
    s_mul_i32 s42, s37, 2
    s_add_u32 s42, s42, 1
    v_xor_b32 v5, s42, v16
    v_lshl_add_u32 v5, v5, 2, v18
    v_lshlrev_b32 v5, 4, v5
    v_and_b32 v6, 1, v17
    v_lshl_add_u32 v5, v6, 3, v5
    v_lshrrev_b32 v6, 1, v15
    v_lshl_add_u32 v6, v6, 3, v16
    v_mul_u32_u24 v6, 256, v6
    v_add_u32 v12, v5, v6
    v_add_u32 v12, 16384, v12
    v_mov_b32 v16, 0
    v_mov_b32 v17, 0
    v_mov_b32 v18, 0
    v_mov_b32 v19, 0
    v_mov_b32 v20, 0
    v_mov_b32 v21, 0
    v_mov_b32 v22, 0
    v_mov_b32 v23, 0
    v_mov_b32 v24, 0
    v_mov_b32 v25, 0
    v_mov_b32 v26, 0
    v_mov_b32 v27, 0
    v_mov_b32 v28, 0
    v_mov_b32 v29, 0
    v_mov_b32 v30, 0
    v_mov_b32 v31, 0
    v_mov_b32 v32, 0
    v_mov_b32 v33, 0
    v_mov_b32 v34, 0
    v_mov_b32 v35, 0
    v_mov_b32 v36, 0
    v_mov_b32 v37, 0
    v_mov_b32 v38, 0
    v_mov_b32 v39, 0
    v_mov_b32 v40, 0
    v_mov_b32 v41, 0
    v_mov_b32 v42, 0
    v_mov_b32 v43, 0
    v_mov_b32 v44, 0
    v_mov_b32 v45, 0
    v_mov_b32 v46, 0
    v_mov_b32 v47, 0
    s_add_u32 s42, s39, 0
    s_add_u32 m0, s41, 0
    s_nop 0
    buffer_load_dwordx4 v2, s[20:23], s42 offen lds
    s_add_u32 s42, s39, 8192
    s_add_u32 m0, s41, 1024
    s_nop 0
    buffer_load_dwordx4 v3, s[20:23], s42 offen lds
    s_add_u32 s42, s40, 0
    s_add_u32 m0, s41, 16384
    s_nop 0
    buffer_load_dwordx4 v4, s[24:27], s42 offen lds
    s_add_u32 s42, s40, 12288
    s_add_u32 m0, s41, 17408
    s_nop 0
    buffer_load_dwordx4 v4, s[24:27], s42 offen lds
    s_add_u32 s42, s39, 128
    s_add_u32 m0, s41, 32768
    s_nop 0
    buffer_load_dwordx4 v2, s[20:23], s42 offen lds
    s_add_u32 s42, s39, 8320
    s_add_u32 m0, s41, 33792
    s_nop 0
    buffer_load_dwordx4 v3, s[20:23], s42 offen lds
    s_add_u32 s42, s40, 196608
    s_add_u32 m0, s41, 49152
    s_nop 0
    buffer_load_dwordx4 v4, s[24:27], s42 offen lds
    s_add_u32 s42, s40, 208896
    s_add_u32 m0, s41, 50176
    s_nop 0
    buffer_load_dwordx4 v4, s[24:27], s42 offen lds
    s_add_u32 s42, s39, 256
    s_add_u32 m0, s41, 65536
    s_nop 0
    buffer_load_dwordx4 v2, s[20:23], s42 offen lds
    s_add_u32 s42, s39, 8448
    s_add_u32 m0, s41, 66560
    s_nop 0
    buffer_load_dwordx4 v3, s[20:23], s42 offen lds
    s_add_u32 s42, s40, 393216
    s_add_u32 m0, s41, 81920
    s_nop 0
    buffer_load_dwordx4 v4, s[24:27], s42 offen lds
    s_add_u32 s42, s40, 405504
    s_add_u32 m0, s41, 82944
    s_nop 0
    buffer_load_dwordx4 v4, s[24:27], s42 offen lds
    s_add_u32 s42, s39, 384
    s_add_u32 m0, s41, 98304
    s_nop 0
    buffer_load_dwordx4 v2, s[20:23], s42 offen lds
    s_add_u32 s42, s39, 8576
    s_add_u32 m0, s41, 99328
    s_nop 0
    buffer_load_dwordx4 v3, s[20:23], s42 offen lds
    s_add_u32 s42, s40, 589824
    s_add_u32 m0, s41, 114688
    s_nop 0
    buffer_load_dwordx4 v4, s[24:27], s42 offen lds
    s_add_u32 s42, s40, 602112
    s_add_u32 m0, s41, 115712
    s_nop 0
    buffer_load_dwordx4 v4, s[24:27], s42 offen lds
    s_waitcnt vmcnt(12)
    s_barrier
    s_add_u32 s42, s39, 512
    s_add_u32 m0, s41, 131072
    s_nop 0
    buffer_load_dwordx4 v2, s[20:23], s42 offen lds
    s_add_u32 s42, s39, 8704
    s_add_u32 m0, s41, 132096
    s_nop 0
    buffer_load_dwordx4 v3, s[20:23], s42 offen lds
    s_add_u32 s42, s40, 786432
    s_add_u32 m0, s41, 147456
    s_nop 0
    buffer_load_dwordx4 v4, s[24:27], s42 offen lds
    s_add_u32 s42, s40, 798720
    s_add_u32 m0, s41, 148480
    s_nop 0
    buffer_load_dwordx4 v4, s[24:27], s42 offen lds
    ds_read_b128 v[48:51], v7 offset:0
    ds_read_b64_tr_b16 v[56:57], v11 offset:0
    ds_read_b64_tr_b16 v[58:59], v11 offset:1024
    ds_read_b64_tr_b16 v[60:61], v12 offset:0
    ds_read_b64_tr_b16 v[62:63], v12 offset:1024
    ds_read_b128 v[52:55], v8 offset:0
    ds_read_b64_tr_b16 v[64:65], v11 offset:4096
    ds_read_b64_tr_b16 v[66:67], v11 offset:5120
    ds_read_b64_tr_b16 v[68:69], v12 offset:4096
    ds_read_b64_tr_b16 v[70:71], v12 offset:5120
    s_waitcnt lgkmcnt(5)
    v_mfma_f32_32x32x16_bf16 v[16:31], v[56:59], v[48:51], v[16:31]
    v_mfma_f32_32x32x16_bf16 v[32:47], v[60:63], v[48:51], v[32:47]
    ds_read_b128 v[48:51], v9 offset:0
    ds_read_b64_tr_b16 v[56:57], v11 offset:8192
    ds_read_b64_tr_b16 v[58:59], v11 offset:9216
    ds_read_b64_tr_b16 v[60:61], v12 offset:8192
    ds_read_b64_tr_b16 v[62:63], v12 offset:9216
    s_waitcnt lgkmcnt(5)
    v_mfma_f32_32x32x16_bf16 v[16:31], v[64:67], v[52:55], v[16:31]
    v_mfma_f32_32x32x16_bf16 v[32:47], v[68:71], v[52:55], v[32:47]
    ds_read_b128 v[52:55], v10 offset:0
    ds_read_b64_tr_b16 v[64:65], v11 offset:12288
    ds_read_b64_tr_b16 v[66:67], v11 offset:13312
    ds_read_b64_tr_b16 v[68:69], v12 offset:12288
    ds_read_b64_tr_b16 v[70:71], v12 offset:13312
    s_waitcnt lgkmcnt(5)
    v_mfma_f32_32x32x16_bf16 v[16:31], v[56:59], v[48:51], v[16:31]
    v_mfma_f32_32x32x16_bf16 v[32:47], v[60:63], v[48:51], v[32:47]
    s_waitcnt lgkmcnt(0)
    v_mfma_f32_32x32x16_bf16 v[16:31], v[64:67], v[52:55], v[16:31]
    v_mfma_f32_32x32x16_bf16 v[32:47], v[68:71], v[52:55], v[32:47]
    s_waitcnt vmcnt(12)
    s_barrier
    s_add_u32 s42, s39, 640
    s_add_u32 m0, s41, 0
    s_nop 0
    buffer_load_dwordx4 v2, s[20:23], s42 offen lds
    s_add_u32 s42, s39, 8832
    s_add_u32 m0, s41, 1024
    s_nop 0
    buffer_load_dwordx4 v3, s[20:23], s42 offen lds
    s_add_u32 s42, s40, 983040
    s_add_u32 m0, s41, 16384
    s_nop 0
    buffer_load_dwordx4 v4, s[24:27], s42 offen lds
    s_add_u32 s42, s40, 995328
    s_add_u32 m0, s41, 17408
    s_nop 0
    buffer_load_dwordx4 v4, s[24:27], s42 offen lds
    v_add_u32 v7, 32768, v7
    v_add_u32 v8, 32768, v8
    v_add_u32 v9, 32768, v9
    v_add_u32 v10, 32768, v10
    v_add_u32 v11, 32768, v11
    v_add_u32 v12, 32768, v12
    ds_read_b128 v[48:51], v7 offset:0
    ds_read_b64_tr_b16 v[56:57], v11 offset:0
    ds_read_b64_tr_b16 v[58:59], v11 offset:1024
    ds_read_b64_tr_b16 v[60:61], v12 offset:0
    ds_read_b64_tr_b16 v[62:63], v12 offset:1024
    ds_read_b128 v[52:55], v8 offset:0
    ds_read_b64_tr_b16 v[64:65], v11 offset:4096
    ds_read_b64_tr_b16 v[66:67], v11 offset:5120
    ds_read_b64_tr_b16 v[68:69], v12 offset:4096
    ds_read_b64_tr_b16 v[70:71], v12 offset:5120
    s_waitcnt lgkmcnt(5)
    v_mfma_f32_32x32x16_bf16 v[16:31], v[56:59], v[48:51], v[16:31]
    v_mfma_f32_32x32x16_bf16 v[32:47], v[60:63], v[48:51], v[32:47]
    ds_read_b128 v[48:51], v9 offset:0
    ds_read_b64_tr_b16 v[56:57], v11 offset:8192
    ds_read_b64_tr_b16 v[58:59], v11 offset:9216
    ds_read_b64_tr_b16 v[60:61], v12 offset:8192
    ds_read_b64_tr_b16 v[62:63], v12 offset:9216
    s_waitcnt lgkmcnt(5)
    v_mfma_f32_32x32x16_bf16 v[16:31], v[64:67], v[52:55], v[16:31]
    v_mfma_f32_32x32x16_bf16 v[32:47], v[68:71], v[52:55], v[32:47]
    ds_read_b128 v[52:55], v10 offset:0
    ds_read_b64_tr_b16 v[64:65], v11 offset:12288
    ds_read_b64_tr_b16 v[66:67], v11 offset:13312
    ds_read_b64_tr_b16 v[68:69], v12 offset:12288
    ds_read_b64_tr_b16 v[70:71], v12 offset:13312
    s_waitcnt lgkmcnt(5)
    v_mfma_f32_32x32x16_bf16 v[16:31], v[56:59], v[48:51], v[16:31]
    v_mfma_f32_32x32x16_bf16 v[32:47], v[60:63], v[48:51], v[32:47]
    s_waitcnt lgkmcnt(0)
    v_mfma_f32_32x32x16_bf16 v[16:31], v[64:67], v[52:55], v[16:31]
    v_mfma_f32_32x32x16_bf16 v[32:47], v[68:71], v[52:55], v[32:47]
    s_waitcnt vmcnt(12)
    s_barrier
    s_add_u32 s42, s39, 768
    s_add_u32 m0, s41, 32768
    s_nop 0
    buffer_load_dwordx4 v2, s[20:23], s42 offen lds
    s_add_u32 s42, s39, 8960
    s_add_u32 m0, s41, 33792
    s_nop 0
    buffer_load_dwordx4 v3, s[20:23], s42 offen lds
    s_add_u32 s42, s40, 1179648
    s_add_u32 m0, s41, 49152
    s_nop 0
    buffer_load_dwordx4 v4, s[24:27], s42 offen lds
    s_add_u32 s42, s40, 1191936
    s_add_u32 m0, s41, 50176
    s_nop 0
    buffer_load_dwordx4 v4, s[24:27], s42 offen lds
    v_add_u32 v7, 32768, v7
    v_add_u32 v8, 32768, v8
    v_add_u32 v9, 32768, v9
    v_add_u32 v10, 32768, v10
    v_add_u32 v11, 32768, v11
    v_add_u32 v12, 32768, v12
    ds_read_b128 v[48:51], v7 offset:0
    ds_read_b64_tr_b16 v[56:57], v11 offset:0
    ds_read_b64_tr_b16 v[58:59], v11 offset:1024
    ds_read_b64_tr_b16 v[60:61], v12 offset:0
    ds_read_b64_tr_b16 v[62:63], v12 offset:1024
    ds_read_b128 v[52:55], v8 offset:0
    ds_read_b64_tr_b16 v[64:65], v11 offset:4096
    ds_read_b64_tr_b16 v[66:67], v11 offset:5120
    ds_read_b64_tr_b16 v[68:69], v12 offset:4096
    ds_read_b64_tr_b16 v[70:71], v12 offset:5120
    s_waitcnt lgkmcnt(5)
    v_mfma_f32_32x32x16_bf16 v[16:31], v[56:59], v[48:51], v[16:31]
    v_mfma_f32_32x32x16_bf16 v[32:47], v[60:63], v[48:51], v[32:47]
    ds_read_b128 v[48:51], v9 offset:0
    ds_read_b64_tr_b16 v[56:57], v11 offset:8192
    ds_read_b64_tr_b16 v[58:59], v11 offset:9216
    ds_read_b64_tr_b16 v[60:61], v12 offset:8192
    ds_read_b64_tr_b16 v[62:63], v12 offset:9216
    s_waitcnt lgkmcnt(5)
    v_mfma_f32_32x32x16_bf16 v[16:31], v[64:67], v[52:55], v[16:31]
    v_mfma_f32_32x32x16_bf16 v[32:47], v[68:71], v[52:55], v[32:47]
    ds_read_b128 v[52:55], v10 offset:0
    ds_read_b64_tr_b16 v[64:65], v11 offset:12288
    ds_read_b64_tr_b16 v[66:67], v11 offset:13312
    ds_read_b64_tr_b16 v[68:69], v12 offset:12288
    ds_read_b64_tr_b16 v[70:71], v12 offset:13312
    s_waitcnt lgkmcnt(5)
    v_mfma_f32_32x32x16_bf16 v[16:31], v[56:59], v[48:51], v[16:31]
    v_mfma_f32_32x32x16_bf16 v[32:47], v[60:63], v[48:51], v[32:47]
    s_waitcnt lgkmcnt(0)
    v_mfma_f32_32x32x16_bf16 v[16:31], v[64:67], v[52:55], v[16:31]
    v_mfma_f32_32x32x16_bf16 v[32:47], v[68:71], v[52:55], v[32:47]
    s_waitcnt vmcnt(12)
    s_barrier
    s_add_u32 s42, s39, 896
    s_add_u32 m0, s41, 65536
    s_nop 0
    buffer_load_dwordx4 v2, s[20:23], s42 offen lds
    s_add_u32 s42, s39, 9088
    s_add_u32 m0, s41, 66560
    s_nop 0
    buffer_load_dwordx4 v3, s[20:23], s42 offen lds
    s_add_u32 s42, s40, 1376256
    s_add_u32 m0, s41, 81920
    s_nop 0
    buffer_load_dwordx4 v4, s[24:27], s42 offen lds
    s_add_u32 s42, s40, 1388544
    s_add_u32 m0, s41, 82944
    s_nop 0
    buffer_load_dwordx4 v4, s[24:27], s42 offen lds
    v_add_u32 v7, 32768, v7
    v_add_u32 v8, 32768, v8
    v_add_u32 v9, 32768, v9
    v_add_u32 v10, 32768, v10
    v_add_u32 v11, 32768, v11
    v_add_u32 v12, 32768, v12
    ds_read_b128 v[48:51], v7 offset:0
    ds_read_b64_tr_b16 v[56:57], v11 offset:0
    ds_read_b64_tr_b16 v[58:59], v11 offset:1024
    ds_read_b64_tr_b16 v[60:61], v12 offset:0
    ds_read_b64_tr_b16 v[62:63], v12 offset:1024
    ds_read_b128 v[52:55], v8 offset:0
    ds_read_b64_tr_b16 v[64:65], v11 offset:4096
    ds_read_b64_tr_b16 v[66:67], v11 offset:5120
    ds_read_b64_tr_b16 v[68:69], v12 offset:4096
    ds_read_b64_tr_b16 v[70:71], v12 offset:5120
    s_waitcnt lgkmcnt(5)
    v_mfma_f32_32x32x16_bf16 v[16:31], v[56:59], v[48:51], v[16:31]
    v_mfma_f32_32x32x16_bf16 v[32:47], v[60:63], v[48:51], v[32:47]
    ds_read_b128 v[48:51], v9 offset:0
    ds_read_b64_tr_b16 v[56:57], v11 offset:8192
    ds_read_b64_tr_b16 v[58:59], v11 offset:9216
    ds_read_b64_tr_b16 v[60:61], v12 offset:8192
    ds_read_b64_tr_b16 v[62:63], v12 offset:9216
    s_waitcnt lgkmcnt(5)
    v_mfma_f32_32x32x16_bf16 v[16:31], v[64:67], v[52:55], v[16:31]
    v_mfma_f32_32x32x16_bf16 v[32:47], v[68:71], v[52:55], v[32:47]
    ds_read_b128 v[52:55], v10 offset:0
    ds_read_b64_tr_b16 v[64:65], v11 offset:12288
    ds_read_b64_tr_b16 v[66:67], v11 offset:13312
    ds_read_b64_tr_b16 v[68:69], v12 offset:12288
    ds_read_b64_tr_b16 v[70:71], v12 offset:13312
    s_waitcnt lgkmcnt(5)
    v_mfma_f32_32x32x16_bf16 v[16:31], v[56:59], v[48:51], v[16:31]
    v_mfma_f32_32x32x16_bf16 v[32:47], v[60:63], v[48:51], v[32:47]
    s_waitcnt lgkmcnt(0)
    v_mfma_f32_32x32x16_bf16 v[16:31], v[64:67], v[52:55], v[16:31]
    v_mfma_f32_32x32x16_bf16 v[32:47], v[68:71], v[52:55], v[32:47]
    s_waitcnt vmcnt(12)
    s_barrier
    v_add_u32 v7, 32768, v7
    v_add_u32 v8, 32768, v8
    v_add_u32 v9, 32768, v9
    v_add_u32 v10, 32768, v10
    v_add_u32 v11, 32768, v11
    v_add_u32 v12, 32768, v12
    ds_read_b128 v[48:51], v7 offset:0
    ds_read_b64_tr_b16 v[56:57], v11 offset:0
    ds_read_b64_tr_b16 v[58:59], v11 offset:1024
    ds_read_b64_tr_b16 v[60:61], v12 offset:0
    ds_read_b64_tr_b16 v[62:63], v12 offset:1024
    ds_read_b128 v[52:55], v8 offset:0
    ds_read_b64_tr_b16 v[64:65], v11 offset:4096
    ds_read_b64_tr_b16 v[66:67], v11 offset:5120
    ds_read_b64_tr_b16 v[68:69], v12 offset:4096
    ds_read_b64_tr_b16 v[70:71], v12 offset:5120
    s_waitcnt lgkmcnt(5)
    v_mfma_f32_32x32x16_bf16 v[16:31], v[56:59], v[48:51], v[16:31]
    v_mfma_f32_32x32x16_bf16 v[32:47], v[60:63], v[48:51], v[32:47]
    ds_read_b128 v[48:51], v9 offset:0
    ds_read_b64_tr_b16 v[56:57], v11 offset:8192
    ds_read_b64_tr_b16 v[58:59], v11 offset:9216
    ds_read_b64_tr_b16 v[60:61], v12 offset:8192
    ds_read_b64_tr_b16 v[62:63], v12 offset:9216
    s_waitcnt lgkmcnt(5)
    v_mfma_f32_32x32x16_bf16 v[16:31], v[64:67], v[52:55], v[16:31]
    v_mfma_f32_32x32x16_bf16 v[32:47], v[68:71], v[52:55], v[32:47]
    ds_read_b128 v[52:55], v10 offset:0
    ds_read_b64_tr_b16 v[64:65], v11 offset:12288
    ds_read_b64_tr_b16 v[66:67], v11 offset:13312
    ds_read_b64_tr_b16 v[68:69], v12 offset:12288
    ds_read_b64_tr_b16 v[70:71], v12 offset:13312
    s_waitcnt lgkmcnt(5)
    v_mfma_f32_32x32x16_bf16 v[16:31], v[56:59], v[48:51], v[16:31]
    v_mfma_f32_32x32x16_bf16 v[32:47], v[60:63], v[48:51], v[32:47]
    s_waitcnt lgkmcnt(0)
    v_mfma_f32_32x32x16_bf16 v[16:31], v[64:67], v[52:55], v[16:31]
    v_mfma_f32_32x32x16_bf16 v[32:47], v[68:71], v[52:55], v[32:47]
    s_waitcnt vmcnt(8)
    s_barrier
    v_add_u32 v7, 4294836224, v7
    v_add_u32 v8, 4294836224, v8
    v_add_u32 v9, 4294836224, v9
    v_add_u32 v10, 4294836224, v10
    v_add_u32 v11, 4294836224, v11
    v_add_u32 v12, 4294836224, v12
    ds_read_b128 v[48:51], v7 offset:0
    ds_read_b64_tr_b16 v[56:57], v11 offset:0
    ds_read_b64_tr_b16 v[58:59], v11 offset:1024
    ds_read_b64_tr_b16 v[60:61], v12 offset:0
    ds_read_b64_tr_b16 v[62:63], v12 offset:1024
    ds_read_b128 v[52:55], v8 offset:0
    ds_read_b64_tr_b16 v[64:65], v11 offset:4096
    ds_read_b64_tr_b16 v[66:67], v11 offset:5120
    ds_read_b64_tr_b16 v[68:69], v12 offset:4096
    ds_read_b64_tr_b16 v[70:71], v12 offset:5120
    s_waitcnt lgkmcnt(5)
    v_mfma_f32_32x32x16_bf16 v[16:31], v[56:59], v[48:51], v[16:31]
    v_mfma_f32_32x32x16_bf16 v[32:47], v[60:63], v[48:51], v[32:47]
    ds_read_b128 v[48:51], v9 offset:0
    ds_read_b64_tr_b16 v[56:57], v11 offset:8192
    ds_read_b64_tr_b16 v[58:59], v11 offset:9216
    ds_read_b64_tr_b16 v[60:61], v12 offset:8192
    ds_read_b64_tr_b16 v[62:63], v12 offset:9216
    s_waitcnt lgkmcnt(5)
    v_mfma_f32_32x32x16_bf16 v[16:31], v[64:67], v[52:55], v[16:31]
    v_mfma_f32_32x32x16_bf16 v[32:47], v[68:71], v[52:55], v[32:47]
    ds_read_b128 v[52:55], v10 offset:0
    ds_read_b64_tr_b16 v[64:65], v11 offset:12288
    ds_read_b64_tr_b16 v[66:67], v11 offset:13312
    ds_read_b64_tr_b16 v[68:69], v12 offset:12288
    ds_read_b64_tr_b16 v[70:71], v12 offset:13312
    s_waitcnt lgkmcnt(5)
    v_mfma_f32_32x32x16_bf16 v[16:31], v[56:59], v[48:51], v[16:31]
    v_mfma_f32_32x32x16_bf16 v[32:47], v[60:63], v[48:51], v[32:47]
    s_waitcnt lgkmcnt(0)
    v_mfma_f32_32x32x16_bf16 v[16:31], v[64:67], v[52:55], v[16:31]
    v_mfma_f32_32x32x16_bf16 v[32:47], v[68:71], v[52:55], v[32:47]
    s_waitcnt vmcnt(4)
    s_barrier
    v_add_u32 v7, 32768, v7
    v_add_u32 v8, 32768, v8
    v_add_u32 v9, 32768, v9
    v_add_u32 v10, 32768, v10
    v_add_u32 v11, 32768, v11
    v_add_u32 v12, 32768, v12
    ds_read_b128 v[48:51], v7 offset:0
    ds_read_b64_tr_b16 v[56:57], v11 offset:0
    ds_read_b64_tr_b16 v[58:59], v11 offset:1024
    ds_read_b64_tr_b16 v[60:61], v12 offset:0
    ds_read_b64_tr_b16 v[62:63], v12 offset:1024
    ds_read_b128 v[52:55], v8 offset:0
    ds_read_b64_tr_b16 v[64:65], v11 offset:4096
    ds_read_b64_tr_b16 v[66:67], v11 offset:5120
    ds_read_b64_tr_b16 v[68:69], v12 offset:4096
    ds_read_b64_tr_b16 v[70:71], v12 offset:5120
    s_waitcnt lgkmcnt(5)
    v_mfma_f32_32x32x16_bf16 v[16:31], v[56:59], v[48:51], v[16:31]
    v_mfma_f32_32x32x16_bf16 v[32:47], v[60:63], v[48:51], v[32:47]
    ds_read_b128 v[48:51], v9 offset:0
    ds_read_b64_tr_b16 v[56:57], v11 offset:8192
    ds_read_b64_tr_b16 v[58:59], v11 offset:9216
    ds_read_b64_tr_b16 v[60:61], v12 offset:8192
    ds_read_b64_tr_b16 v[62:63], v12 offset:9216
    s_waitcnt lgkmcnt(5)
    v_mfma_f32_32x32x16_bf16 v[16:31], v[64:67], v[52:55], v[16:31]
    v_mfma_f32_32x32x16_bf16 v[32:47], v[68:71], v[52:55], v[32:47]
    ds_read_b128 v[52:55], v10 offset:0
    ds_read_b64_tr_b16 v[64:65], v11 offset:12288
    ds_read_b64_tr_b16 v[66:67], v11 offset:13312
    ds_read_b64_tr_b16 v[68:69], v12 offset:12288
    ds_read_b64_tr_b16 v[70:71], v12 offset:13312
    s_waitcnt lgkmcnt(5)
    v_mfma_f32_32x32x16_bf16 v[16:31], v[56:59], v[48:51], v[16:31]
    v_mfma_f32_32x32x16_bf16 v[32:47], v[60:63], v[48:51], v[32:47]
    s_waitcnt lgkmcnt(0)
    v_mfma_f32_32x32x16_bf16 v[16:31], v[64:67], v[52:55], v[16:31]
    v_mfma_f32_32x32x16_bf16 v[32:47], v[68:71], v[52:55], v[32:47]
    s_waitcnt vmcnt(0)
    s_barrier
    v_add_u32 v7, 32768, v7
    v_add_u32 v8, 32768, v8
    v_add_u32 v9, 32768, v9
    v_add_u32 v10, 32768, v10
    v_add_u32 v11, 32768, v11
    v_add_u32 v12, 32768, v12
    ds_read_b128 v[48:51], v7 offset:0
    ds_read_b64_tr_b16 v[56:57], v11 offset:0
    ds_read_b64_tr_b16 v[58:59], v11 offset:1024
    ds_read_b64_tr_b16 v[60:61], v12 offset:0
    ds_read_b64_tr_b16 v[62:63], v12 offset:1024
    ds_read_b128 v[52:55], v8 offset:0
    ds_read_b64_tr_b16 v[64:65], v11 offset:4096
    ds_read_b64_tr_b16 v[66:67], v11 offset:5120
    ds_read_b64_tr_b16 v[68:69], v12 offset:4096
    ds_read_b64_tr_b16 v[70:71], v12 offset:5120
    s_waitcnt lgkmcnt(5)
    v_mfma_f32_32x32x16_bf16 v[16:31], v[56:59], v[48:51], v[16:31]
    v_mfma_f32_32x32x16_bf16 v[32:47], v[60:63], v[48:51], v[32:47]
    ds_read_b128 v[48:51], v9 offset:0
    ds_read_b64_tr_b16 v[56:57], v11 offset:8192
    ds_read_b64_tr_b16 v[58:59], v11 offset:9216
    ds_read_b64_tr_b16 v[60:61], v12 offset:8192
    ds_read_b64_tr_b16 v[62:63], v12 offset:9216
    s_waitcnt lgkmcnt(5)
    v_mfma_f32_32x32x16_bf16 v[16:31], v[64:67], v[52:55], v[16:31]
    v_mfma_f32_32x32x16_bf16 v[32:47], v[68:71], v[52:55], v[32:47]
    ds_read_b128 v[52:55], v10 offset:0
    ds_read_b64_tr_b16 v[64:65], v11 offset:12288
    ds_read_b64_tr_b16 v[66:67], v11 offset:13312
    ds_read_b64_tr_b16 v[68:69], v12 offset:12288
    ds_read_b64_tr_b16 v[70:71], v12 offset:13312
    s_waitcnt lgkmcnt(5)
    v_mfma_f32_32x32x16_bf16 v[16:31], v[56:59], v[48:51], v[16:31]
    v_mfma_f32_32x32x16_bf16 v[32:47], v[60:63], v[48:51], v[32:47]
    s_waitcnt lgkmcnt(0)
    v_mfma_f32_32x32x16_bf16 v[16:31], v[64:67], v[52:55], v[16:31]
    v_mfma_f32_32x32x16_bf16 v[32:47], v[68:71], v[52:55], v[32:47]
    v_lshlrev_b32 v2, 5, v13
    v_lshl_add_u32 v2, v14, 3, v2
    s_lshr_b32 s44, s19, 2
    s_lshl_b32 s43, s44, 21
    s_and_b32 s44, s33, 511
    s_lshl_b32 s44, s44, 12
    s_add_u32 s43, s43, s44
    s_lshl_b32 s44, s36, 5
    s_add_u32 s44, s44, s32
    s_lshl_b32 s44, s44, 5
    s_add_u32 s43, s43, s44
    s_lshl_b32 s44, s37, 18
    s_add_u32 s43, s43, s44
    v_cvt_pk_bf16_f32 v4, v16, v17
    v_cvt_pk_bf16_f32 v5, v18, v19
    s_add_u32 s45, s43, 0
    buffer_store_dwordx2 v[4:5], v2, s[28:31], s45 offen offset:0
    v_cvt_pk_bf16_f32 v4, v20, v21
    v_cvt_pk_bf16_f32 v5, v22, v23
    s_add_u32 s45, s43, 0
    buffer_store_dwordx2 v[4:5], v2, s[28:31], s45 offen offset:16
    v_cvt_pk_bf16_f32 v4, v24, v25
    v_cvt_pk_bf16_f32 v5, v26, v27
    s_add_u32 s45, s43, 65536
    buffer_store_dwordx2 v[4:5], v2, s[28:31], s45 offen offset:0
    v_cvt_pk_bf16_f32 v4, v28, v29
    v_cvt_pk_bf16_f32 v5, v30, v31
    s_add_u32 s45, s43, 65536
    buffer_store_dwordx2 v[4:5], v2, s[28:31], s45 offen offset:16
    v_cvt_pk_bf16_f32 v4, v32, v33
    v_cvt_pk_bf16_f32 v5, v34, v35
    s_add_u32 s45, s43, 131072
    buffer_store_dwordx2 v[4:5], v2, s[28:31], s45 offen offset:0
    v_cvt_pk_bf16_f32 v4, v36, v37
    v_cvt_pk_bf16_f32 v5, v38, v39
    s_add_u32 s45, s43, 131072
    buffer_store_dwordx2 v[4:5], v2, s[28:31], s45 offen offset:16
    v_cvt_pk_bf16_f32 v4, v40, v41
    v_cvt_pk_bf16_f32 v5, v42, v43
    s_add_u32 s45, s43, 196608
    buffer_store_dwordx2 v[4:5], v2, s[28:31], s45 offen offset:0
    v_cvt_pk_bf16_f32 v4, v44, v45
    v_cvt_pk_bf16_f32 v5, v46, v47
    s_add_u32 s45, s43, 196608
    buffer_store_dwordx2 v[4:5], v2, s[28:31], s45 offen offset:16
    s_endpgm
k1_qkv_prep_kernel_vtype3:
    s_lshr_b32 s36, s3, 1
    s_and_b32 s37, s3, 1
    v_lshrrev_b32 v5, 4, v1
    v_and_b32 v5, 7, v5
    v_and_b32 v6, 7, v1
    v_xor_b32 v5, v5, v6
    v_lshlrev_b32 v5, 4, v5
    v_lshrrev_b32 v6, 3, v1
    v_lshl_add_u32 v2, v6, 10, v5
    v_lshrrev_b32 v5, 4, v1
    v_add_u32 v5, 4, v5
    v_and_b32 v5, 7, v5
    v_and_b32 v6, 7, v1
    v_xor_b32 v5, v5, v6
    v_lshlrev_b32 v5, 4, v5
    v_lshrrev_b32 v6, 3, v1
    v_lshl_add_u32 v3, v6, 10, v5
    v_lshrrev_b32 v5, 4, v1
    v_lshlrev_b32 v6, 2, v5
    v_and_b32 v4, 15, v1
    v_xor_b32 v4, v4, v6
    v_lshlrev_b32 v4, 4, v4
    s_mov_b32 s38, 3072
    v_mul_lo_u32 v5, v5, s38
    v_add_u32 v4, v4, v5
    s_mul_i32 s39, s3, 16384
    s_add_u32 s39, s39, s34
    s_mul_i32 s40, s3, 24576
    s_add_u32 s40, s40, s35
    s_lshl_b32 s41, s3, 11
    v_and_b32 v13, 31, v1
    v_lshrrev_b32 v14, 5, v1
    v_lshrrev_b32 v5, 1, v1
    v_and_b32 v5, 7, v5
    s_mul_i32 s42, s36, 4096
    s_add_u32 s42, s42, 0
    v_add_u32 v6, 0, v14
    v_xor_b32 v6, v6, v5
    v_lshlrev_b32 v6, 4, v6
    v_lshl_add_u32 v7, v13, 7, v6
    v_add_u32 v7, s42, v7
    v_add_u32 v6, 2, v14
    v_xor_b32 v6, v6, v5
    v_lshlrev_b32 v6, 4, v6
    v_lshl_add_u32 v8, v13, 7, v6
    v_add_u32 v8, s42, v8
    v_add_u32 v6, 4, v14
    v_xor_b32 v6, v6, v5
    v_lshlrev_b32 v6, 4, v6
    v_lshl_add_u32 v9, v13, 7, v6
    v_add_u32 v9, s42, v9
    v_add_u32 v6, 6, v14
    v_xor_b32 v6, v6, v5
    v_lshlrev_b32 v6, 4, v6
    v_lshl_add_u32 v10, v13, 7, v6
    v_add_u32 v10, s42, v10
    v_lshrrev_b32 v15, 4, v1
    v_and_b32 v17, 15, v1
    v_lshrrev_b32 v16, 2, v17
    v_and_b32 v17, 3, v17
    v_and_b32 v18, 1, v15
    v_lshlrev_b32 v18, 1, v18
    v_lshrrev_b32 v5, 1, v17
    v_add_u32 v18, v18, v5
    s_mul_i32 s42, s37, 2
    s_add_u32 s42, s42, 0
    v_xor_b32 v5, s42, v16
    v_lshl_add_u32 v5, v5, 2, v18
    v_lshlrev_b32 v5, 4, v5
    v_and_b32 v6, 1, v17
    v_lshl_add_u32 v5, v6, 3, v5
    v_lshrrev_b32 v6, 1, v15
    v_lshl_add_u32 v6, v6, 3, v16
    v_mul_u32_u24 v6, 256, v6
    v_add_u32 v11, v5, v6
    v_add_u32 v11, 16384, v11
    s_mul_i32 s42, s37, 2
    s_add_u32 s42, s42, 1
    v_xor_b32 v5, s42, v16
    v_lshl_add_u32 v5, v5, 2, v18
    v_lshlrev_b32 v5, 4, v5
    v_and_b32 v6, 1, v17
    v_lshl_add_u32 v5, v6, 3, v5
    v_lshrrev_b32 v6, 1, v15
    v_lshl_add_u32 v6, v6, 3, v16
    v_mul_u32_u24 v6, 256, v6
    v_add_u32 v12, v5, v6
    v_add_u32 v12, 16384, v12
    v_mov_b32 v16, 0
    v_mov_b32 v17, 0
    v_mov_b32 v18, 0
    v_mov_b32 v19, 0
    v_mov_b32 v20, 0
    v_mov_b32 v21, 0
    v_mov_b32 v22, 0
    v_mov_b32 v23, 0
    v_mov_b32 v24, 0
    v_mov_b32 v25, 0
    v_mov_b32 v26, 0
    v_mov_b32 v27, 0
    v_mov_b32 v28, 0
    v_mov_b32 v29, 0
    v_mov_b32 v30, 0
    v_mov_b32 v31, 0
    v_mov_b32 v32, 0
    v_mov_b32 v33, 0
    v_mov_b32 v34, 0
    v_mov_b32 v35, 0
    v_mov_b32 v36, 0
    v_mov_b32 v37, 0
    v_mov_b32 v38, 0
    v_mov_b32 v39, 0
    v_mov_b32 v40, 0
    v_mov_b32 v41, 0
    v_mov_b32 v42, 0
    v_mov_b32 v43, 0
    v_mov_b32 v44, 0
    v_mov_b32 v45, 0
    v_mov_b32 v46, 0
    v_mov_b32 v47, 0
    s_add_u32 s42, s39, 0
    s_add_u32 m0, s41, 0
    s_nop 0
    buffer_load_dwordx4 v2, s[20:23], s42 offen lds
    s_add_u32 s42, s39, 8192
    s_add_u32 m0, s41, 1024
    s_nop 0
    buffer_load_dwordx4 v3, s[20:23], s42 offen lds
    s_add_u32 s42, s40, 0
    s_add_u32 m0, s41, 16384
    s_nop 0
    buffer_load_dwordx4 v4, s[24:27], s42 offen lds
    s_add_u32 s42, s40, 12288
    s_add_u32 m0, s41, 17408
    s_nop 0
    buffer_load_dwordx4 v4, s[24:27], s42 offen lds
    s_add_u32 s42, s39, 128
    s_add_u32 m0, s41, 32768
    s_nop 0
    buffer_load_dwordx4 v2, s[20:23], s42 offen lds
    s_add_u32 s42, s39, 8320
    s_add_u32 m0, s41, 33792
    s_nop 0
    buffer_load_dwordx4 v3, s[20:23], s42 offen lds
    s_add_u32 s42, s40, 196608
    s_add_u32 m0, s41, 49152
    s_nop 0
    buffer_load_dwordx4 v4, s[24:27], s42 offen lds
    s_add_u32 s42, s40, 208896
    s_add_u32 m0, s41, 50176
    s_nop 0
    buffer_load_dwordx4 v4, s[24:27], s42 offen lds
    s_add_u32 s42, s39, 256
    s_add_u32 m0, s41, 65536
    s_nop 0
    buffer_load_dwordx4 v2, s[20:23], s42 offen lds
    s_add_u32 s42, s39, 8448
    s_add_u32 m0, s41, 66560
    s_nop 0
    buffer_load_dwordx4 v3, s[20:23], s42 offen lds
    s_add_u32 s42, s40, 393216
    s_add_u32 m0, s41, 81920
    s_nop 0
    buffer_load_dwordx4 v4, s[24:27], s42 offen lds
    s_add_u32 s42, s40, 405504
    s_add_u32 m0, s41, 82944
    s_nop 0
    buffer_load_dwordx4 v4, s[24:27], s42 offen lds
    s_add_u32 s42, s39, 384
    s_add_u32 m0, s41, 98304
    s_nop 0
    buffer_load_dwordx4 v2, s[20:23], s42 offen lds
    s_add_u32 s42, s39, 8576
    s_add_u32 m0, s41, 99328
    s_nop 0
    buffer_load_dwordx4 v3, s[20:23], s42 offen lds
    s_add_u32 s42, s40, 589824
    s_add_u32 m0, s41, 114688
    s_nop 0
    buffer_load_dwordx4 v4, s[24:27], s42 offen lds
    s_add_u32 s42, s40, 602112
    s_add_u32 m0, s41, 115712
    s_nop 0
    buffer_load_dwordx4 v4, s[24:27], s42 offen lds
    s_waitcnt vmcnt(12)
    s_barrier
    s_add_u32 s42, s39, 512
    s_add_u32 m0, s41, 131072
    s_nop 0
    buffer_load_dwordx4 v2, s[20:23], s42 offen lds
    s_add_u32 s42, s39, 8704
    s_add_u32 m0, s41, 132096
    s_nop 0
    buffer_load_dwordx4 v3, s[20:23], s42 offen lds
    s_add_u32 s42, s40, 786432
    s_add_u32 m0, s41, 147456
    s_nop 0
    buffer_load_dwordx4 v4, s[24:27], s42 offen lds
    s_add_u32 s42, s40, 798720
    s_add_u32 m0, s41, 148480
    s_nop 0
    buffer_load_dwordx4 v4, s[24:27], s42 offen lds
    ds_read_b128 v[48:51], v7 offset:0
    ds_read_b64_tr_b16 v[56:57], v11 offset:0
    ds_read_b64_tr_b16 v[58:59], v11 offset:1024
    ds_read_b64_tr_b16 v[60:61], v12 offset:0
    ds_read_b64_tr_b16 v[62:63], v12 offset:1024
    ds_read_b128 v[52:55], v8 offset:0
    ds_read_b64_tr_b16 v[64:65], v11 offset:4096
    ds_read_b64_tr_b16 v[66:67], v11 offset:5120
    ds_read_b64_tr_b16 v[68:69], v12 offset:4096
    ds_read_b64_tr_b16 v[70:71], v12 offset:5120
    s_waitcnt lgkmcnt(5)
    v_mfma_f32_32x32x16_bf16 v[16:31], v[48:51], v[56:59], v[16:31]
    v_mfma_f32_32x32x16_bf16 v[32:47], v[48:51], v[60:63], v[32:47]
    ds_read_b128 v[48:51], v9 offset:0
    ds_read_b64_tr_b16 v[56:57], v11 offset:8192
    ds_read_b64_tr_b16 v[58:59], v11 offset:9216
    ds_read_b64_tr_b16 v[60:61], v12 offset:8192
    ds_read_b64_tr_b16 v[62:63], v12 offset:9216
    s_waitcnt lgkmcnt(5)
    v_mfma_f32_32x32x16_bf16 v[16:31], v[52:55], v[64:67], v[16:31]
    v_mfma_f32_32x32x16_bf16 v[32:47], v[52:55], v[68:71], v[32:47]
    ds_read_b128 v[52:55], v10 offset:0
    ds_read_b64_tr_b16 v[64:65], v11 offset:12288
    ds_read_b64_tr_b16 v[66:67], v11 offset:13312
    ds_read_b64_tr_b16 v[68:69], v12 offset:12288
    ds_read_b64_tr_b16 v[70:71], v12 offset:13312
    s_waitcnt lgkmcnt(5)
    v_mfma_f32_32x32x16_bf16 v[16:31], v[48:51], v[56:59], v[16:31]
    v_mfma_f32_32x32x16_bf16 v[32:47], v[48:51], v[60:63], v[32:47]
    s_waitcnt lgkmcnt(0)
    v_mfma_f32_32x32x16_bf16 v[16:31], v[52:55], v[64:67], v[16:31]
    v_mfma_f32_32x32x16_bf16 v[32:47], v[52:55], v[68:71], v[32:47]
    s_waitcnt vmcnt(12)
    s_barrier
    s_add_u32 s42, s39, 640
    s_add_u32 m0, s41, 0
    s_nop 0
    buffer_load_dwordx4 v2, s[20:23], s42 offen lds
    s_add_u32 s42, s39, 8832
    s_add_u32 m0, s41, 1024
    s_nop 0
    buffer_load_dwordx4 v3, s[20:23], s42 offen lds
    s_add_u32 s42, s40, 983040
    s_add_u32 m0, s41, 16384
    s_nop 0
    buffer_load_dwordx4 v4, s[24:27], s42 offen lds
    s_add_u32 s42, s40, 995328
    s_add_u32 m0, s41, 17408
    s_nop 0
    buffer_load_dwordx4 v4, s[24:27], s42 offen lds
    v_add_u32 v7, 32768, v7
    v_add_u32 v8, 32768, v8
    v_add_u32 v9, 32768, v9
    v_add_u32 v10, 32768, v10
    v_add_u32 v11, 32768, v11
    v_add_u32 v12, 32768, v12
    ds_read_b128 v[48:51], v7 offset:0
    ds_read_b64_tr_b16 v[56:57], v11 offset:0
    ds_read_b64_tr_b16 v[58:59], v11 offset:1024
    ds_read_b64_tr_b16 v[60:61], v12 offset:0
    ds_read_b64_tr_b16 v[62:63], v12 offset:1024
    ds_read_b128 v[52:55], v8 offset:0
    ds_read_b64_tr_b16 v[64:65], v11 offset:4096
    ds_read_b64_tr_b16 v[66:67], v11 offset:5120
    ds_read_b64_tr_b16 v[68:69], v12 offset:4096
    ds_read_b64_tr_b16 v[70:71], v12 offset:5120
    s_waitcnt lgkmcnt(5)
    v_mfma_f32_32x32x16_bf16 v[16:31], v[48:51], v[56:59], v[16:31]
    v_mfma_f32_32x32x16_bf16 v[32:47], v[48:51], v[60:63], v[32:47]
    ds_read_b128 v[48:51], v9 offset:0
    ds_read_b64_tr_b16 v[56:57], v11 offset:8192
    ds_read_b64_tr_b16 v[58:59], v11 offset:9216
    ds_read_b64_tr_b16 v[60:61], v12 offset:8192
    ds_read_b64_tr_b16 v[62:63], v12 offset:9216
    s_waitcnt lgkmcnt(5)
    v_mfma_f32_32x32x16_bf16 v[16:31], v[52:55], v[64:67], v[16:31]
    v_mfma_f32_32x32x16_bf16 v[32:47], v[52:55], v[68:71], v[32:47]
    ds_read_b128 v[52:55], v10 offset:0
    ds_read_b64_tr_b16 v[64:65], v11 offset:12288
    ds_read_b64_tr_b16 v[66:67], v11 offset:13312
    ds_read_b64_tr_b16 v[68:69], v12 offset:12288
    ds_read_b64_tr_b16 v[70:71], v12 offset:13312
    s_waitcnt lgkmcnt(5)
    v_mfma_f32_32x32x16_bf16 v[16:31], v[48:51], v[56:59], v[16:31]
    v_mfma_f32_32x32x16_bf16 v[32:47], v[48:51], v[60:63], v[32:47]
    s_waitcnt lgkmcnt(0)
    v_mfma_f32_32x32x16_bf16 v[16:31], v[52:55], v[64:67], v[16:31]
    v_mfma_f32_32x32x16_bf16 v[32:47], v[52:55], v[68:71], v[32:47]
    s_waitcnt vmcnt(12)
    s_barrier
    s_add_u32 s42, s39, 768
    s_add_u32 m0, s41, 32768
    s_nop 0
    buffer_load_dwordx4 v2, s[20:23], s42 offen lds
    s_add_u32 s42, s39, 8960
    s_add_u32 m0, s41, 33792
    s_nop 0
    buffer_load_dwordx4 v3, s[20:23], s42 offen lds
    s_add_u32 s42, s40, 1179648
    s_add_u32 m0, s41, 49152
    s_nop 0
    buffer_load_dwordx4 v4, s[24:27], s42 offen lds
    s_add_u32 s42, s40, 1191936
    s_add_u32 m0, s41, 50176
    s_nop 0
    buffer_load_dwordx4 v4, s[24:27], s42 offen lds
    v_add_u32 v7, 32768, v7
    v_add_u32 v8, 32768, v8
    v_add_u32 v9, 32768, v9
    v_add_u32 v10, 32768, v10
    v_add_u32 v11, 32768, v11
    v_add_u32 v12, 32768, v12
    ds_read_b128 v[48:51], v7 offset:0
    ds_read_b64_tr_b16 v[56:57], v11 offset:0
    ds_read_b64_tr_b16 v[58:59], v11 offset:1024
    ds_read_b64_tr_b16 v[60:61], v12 offset:0
    ds_read_b64_tr_b16 v[62:63], v12 offset:1024
    ds_read_b128 v[52:55], v8 offset:0
    ds_read_b64_tr_b16 v[64:65], v11 offset:4096
    ds_read_b64_tr_b16 v[66:67], v11 offset:5120
    ds_read_b64_tr_b16 v[68:69], v12 offset:4096
    ds_read_b64_tr_b16 v[70:71], v12 offset:5120
    s_waitcnt lgkmcnt(5)
    v_mfma_f32_32x32x16_bf16 v[16:31], v[48:51], v[56:59], v[16:31]
    v_mfma_f32_32x32x16_bf16 v[32:47], v[48:51], v[60:63], v[32:47]
    ds_read_b128 v[48:51], v9 offset:0
    ds_read_b64_tr_b16 v[56:57], v11 offset:8192
    ds_read_b64_tr_b16 v[58:59], v11 offset:9216
    ds_read_b64_tr_b16 v[60:61], v12 offset:8192
    ds_read_b64_tr_b16 v[62:63], v12 offset:9216
    s_waitcnt lgkmcnt(5)
    v_mfma_f32_32x32x16_bf16 v[16:31], v[52:55], v[64:67], v[16:31]
    v_mfma_f32_32x32x16_bf16 v[32:47], v[52:55], v[68:71], v[32:47]
    ds_read_b128 v[52:55], v10 offset:0
    ds_read_b64_tr_b16 v[64:65], v11 offset:12288
    ds_read_b64_tr_b16 v[66:67], v11 offset:13312
    ds_read_b64_tr_b16 v[68:69], v12 offset:12288
    ds_read_b64_tr_b16 v[70:71], v12 offset:13312
    s_waitcnt lgkmcnt(5)
    v_mfma_f32_32x32x16_bf16 v[16:31], v[48:51], v[56:59], v[16:31]
    v_mfma_f32_32x32x16_bf16 v[32:47], v[48:51], v[60:63], v[32:47]
    s_waitcnt lgkmcnt(0)
    v_mfma_f32_32x32x16_bf16 v[16:31], v[52:55], v[64:67], v[16:31]
    v_mfma_f32_32x32x16_bf16 v[32:47], v[52:55], v[68:71], v[32:47]
    s_waitcnt vmcnt(12)
    s_barrier
    s_add_u32 s42, s39, 896
    s_add_u32 m0, s41, 65536
    s_nop 0
    buffer_load_dwordx4 v2, s[20:23], s42 offen lds
    s_add_u32 s42, s39, 9088
    s_add_u32 m0, s41, 66560
    s_nop 0
    buffer_load_dwordx4 v3, s[20:23], s42 offen lds
    s_add_u32 s42, s40, 1376256
    s_add_u32 m0, s41, 81920
    s_nop 0
    buffer_load_dwordx4 v4, s[24:27], s42 offen lds
    s_add_u32 s42, s40, 1388544
    s_add_u32 m0, s41, 82944
    s_nop 0
    buffer_load_dwordx4 v4, s[24:27], s42 offen lds
    v_add_u32 v7, 32768, v7
    v_add_u32 v8, 32768, v8
    v_add_u32 v9, 32768, v9
    v_add_u32 v10, 32768, v10
    v_add_u32 v11, 32768, v11
    v_add_u32 v12, 32768, v12
    ds_read_b128 v[48:51], v7 offset:0
    ds_read_b64_tr_b16 v[56:57], v11 offset:0
    ds_read_b64_tr_b16 v[58:59], v11 offset:1024
    ds_read_b64_tr_b16 v[60:61], v12 offset:0
    ds_read_b64_tr_b16 v[62:63], v12 offset:1024
    ds_read_b128 v[52:55], v8 offset:0
    ds_read_b64_tr_b16 v[64:65], v11 offset:4096
    ds_read_b64_tr_b16 v[66:67], v11 offset:5120
    ds_read_b64_tr_b16 v[68:69], v12 offset:4096
    ds_read_b64_tr_b16 v[70:71], v12 offset:5120
    s_waitcnt lgkmcnt(5)
    v_mfma_f32_32x32x16_bf16 v[16:31], v[48:51], v[56:59], v[16:31]
    v_mfma_f32_32x32x16_bf16 v[32:47], v[48:51], v[60:63], v[32:47]
    ds_read_b128 v[48:51], v9 offset:0
    ds_read_b64_tr_b16 v[56:57], v11 offset:8192
    ds_read_b64_tr_b16 v[58:59], v11 offset:9216
    ds_read_b64_tr_b16 v[60:61], v12 offset:8192
    ds_read_b64_tr_b16 v[62:63], v12 offset:9216
    s_waitcnt lgkmcnt(5)
    v_mfma_f32_32x32x16_bf16 v[16:31], v[52:55], v[64:67], v[16:31]
    v_mfma_f32_32x32x16_bf16 v[32:47], v[52:55], v[68:71], v[32:47]
    ds_read_b128 v[52:55], v10 offset:0
    ds_read_b64_tr_b16 v[64:65], v11 offset:12288
    ds_read_b64_tr_b16 v[66:67], v11 offset:13312
    ds_read_b64_tr_b16 v[68:69], v12 offset:12288
    ds_read_b64_tr_b16 v[70:71], v12 offset:13312
    s_waitcnt lgkmcnt(5)
    v_mfma_f32_32x32x16_bf16 v[16:31], v[48:51], v[56:59], v[16:31]
    v_mfma_f32_32x32x16_bf16 v[32:47], v[48:51], v[60:63], v[32:47]
    s_waitcnt lgkmcnt(0)
    v_mfma_f32_32x32x16_bf16 v[16:31], v[52:55], v[64:67], v[16:31]
    v_mfma_f32_32x32x16_bf16 v[32:47], v[52:55], v[68:71], v[32:47]
    s_waitcnt vmcnt(12)
    s_barrier
    v_add_u32 v7, 32768, v7
    v_add_u32 v8, 32768, v8
    v_add_u32 v9, 32768, v9
    v_add_u32 v10, 32768, v10
    v_add_u32 v11, 32768, v11
    v_add_u32 v12, 32768, v12
    ds_read_b128 v[48:51], v7 offset:0
    ds_read_b64_tr_b16 v[56:57], v11 offset:0
    ds_read_b64_tr_b16 v[58:59], v11 offset:1024
    ds_read_b64_tr_b16 v[60:61], v12 offset:0
    ds_read_b64_tr_b16 v[62:63], v12 offset:1024
    ds_read_b128 v[52:55], v8 offset:0
    ds_read_b64_tr_b16 v[64:65], v11 offset:4096
    ds_read_b64_tr_b16 v[66:67], v11 offset:5120
    ds_read_b64_tr_b16 v[68:69], v12 offset:4096
    ds_read_b64_tr_b16 v[70:71], v12 offset:5120
    s_waitcnt lgkmcnt(5)
    v_mfma_f32_32x32x16_bf16 v[16:31], v[48:51], v[56:59], v[16:31]
    v_mfma_f32_32x32x16_bf16 v[32:47], v[48:51], v[60:63], v[32:47]
    ds_read_b128 v[48:51], v9 offset:0
    ds_read_b64_tr_b16 v[56:57], v11 offset:8192
    ds_read_b64_tr_b16 v[58:59], v11 offset:9216
    ds_read_b64_tr_b16 v[60:61], v12 offset:8192
    ds_read_b64_tr_b16 v[62:63], v12 offset:9216
    s_waitcnt lgkmcnt(5)
    v_mfma_f32_32x32x16_bf16 v[16:31], v[52:55], v[64:67], v[16:31]
    v_mfma_f32_32x32x16_bf16 v[32:47], v[52:55], v[68:71], v[32:47]
    ds_read_b128 v[52:55], v10 offset:0
    ds_read_b64_tr_b16 v[64:65], v11 offset:12288
    ds_read_b64_tr_b16 v[66:67], v11 offset:13312
    ds_read_b64_tr_b16 v[68:69], v12 offset:12288
    ds_read_b64_tr_b16 v[70:71], v12 offset:13312
    s_waitcnt lgkmcnt(5)
    v_mfma_f32_32x32x16_bf16 v[16:31], v[48:51], v[56:59], v[16:31]
    v_mfma_f32_32x32x16_bf16 v[32:47], v[48:51], v[60:63], v[32:47]
    s_waitcnt lgkmcnt(0)
    v_mfma_f32_32x32x16_bf16 v[16:31], v[52:55], v[64:67], v[16:31]
    v_mfma_f32_32x32x16_bf16 v[32:47], v[52:55], v[68:71], v[32:47]
    s_waitcnt vmcnt(8)
    s_barrier
    v_add_u32 v7, 4294836224, v7
    v_add_u32 v8, 4294836224, v8
    v_add_u32 v9, 4294836224, v9
    v_add_u32 v10, 4294836224, v10
    v_add_u32 v11, 4294836224, v11
    v_add_u32 v12, 4294836224, v12
    ds_read_b128 v[48:51], v7 offset:0
    ds_read_b64_tr_b16 v[56:57], v11 offset:0
    ds_read_b64_tr_b16 v[58:59], v11 offset:1024
    ds_read_b64_tr_b16 v[60:61], v12 offset:0
    ds_read_b64_tr_b16 v[62:63], v12 offset:1024
    ds_read_b128 v[52:55], v8 offset:0
    ds_read_b64_tr_b16 v[64:65], v11 offset:4096
    ds_read_b64_tr_b16 v[66:67], v11 offset:5120
    ds_read_b64_tr_b16 v[68:69], v12 offset:4096
    ds_read_b64_tr_b16 v[70:71], v12 offset:5120
    s_waitcnt lgkmcnt(5)
    v_mfma_f32_32x32x16_bf16 v[16:31], v[48:51], v[56:59], v[16:31]
    v_mfma_f32_32x32x16_bf16 v[32:47], v[48:51], v[60:63], v[32:47]
    ds_read_b128 v[48:51], v9 offset:0
    ds_read_b64_tr_b16 v[56:57], v11 offset:8192
    ds_read_b64_tr_b16 v[58:59], v11 offset:9216
    ds_read_b64_tr_b16 v[60:61], v12 offset:8192
    ds_read_b64_tr_b16 v[62:63], v12 offset:9216
    s_waitcnt lgkmcnt(5)
    v_mfma_f32_32x32x16_bf16 v[16:31], v[52:55], v[64:67], v[16:31]
    v_mfma_f32_32x32x16_bf16 v[32:47], v[52:55], v[68:71], v[32:47]
    ds_read_b128 v[52:55], v10 offset:0
    ds_read_b64_tr_b16 v[64:65], v11 offset:12288
    ds_read_b64_tr_b16 v[66:67], v11 offset:13312
    ds_read_b64_tr_b16 v[68:69], v12 offset:12288
    ds_read_b64_tr_b16 v[70:71], v12 offset:13312
    s_waitcnt lgkmcnt(5)
    v_mfma_f32_32x32x16_bf16 v[16:31], v[48:51], v[56:59], v[16:31]
    v_mfma_f32_32x32x16_bf16 v[32:47], v[48:51], v[60:63], v[32:47]
    s_waitcnt lgkmcnt(0)
    v_mfma_f32_32x32x16_bf16 v[16:31], v[52:55], v[64:67], v[16:31]
    v_mfma_f32_32x32x16_bf16 v[32:47], v[52:55], v[68:71], v[32:47]
    s_waitcnt vmcnt(4)
    s_barrier
    v_add_u32 v7, 32768, v7
    v_add_u32 v8, 32768, v8
    v_add_u32 v9, 32768, v9
    v_add_u32 v10, 32768, v10
    v_add_u32 v11, 32768, v11
    v_add_u32 v12, 32768, v12
    ds_read_b128 v[48:51], v7 offset:0
    ds_read_b64_tr_b16 v[56:57], v11 offset:0
    ds_read_b64_tr_b16 v[58:59], v11 offset:1024
    ds_read_b64_tr_b16 v[60:61], v12 offset:0
    ds_read_b64_tr_b16 v[62:63], v12 offset:1024
    ds_read_b128 v[52:55], v8 offset:0
    ds_read_b64_tr_b16 v[64:65], v11 offset:4096
    ds_read_b64_tr_b16 v[66:67], v11 offset:5120
    ds_read_b64_tr_b16 v[68:69], v12 offset:4096
    ds_read_b64_tr_b16 v[70:71], v12 offset:5120
    s_waitcnt lgkmcnt(5)
    v_mfma_f32_32x32x16_bf16 v[16:31], v[48:51], v[56:59], v[16:31]
    v_mfma_f32_32x32x16_bf16 v[32:47], v[48:51], v[60:63], v[32:47]
    ds_read_b128 v[48:51], v9 offset:0
    ds_read_b64_tr_b16 v[56:57], v11 offset:8192
    ds_read_b64_tr_b16 v[58:59], v11 offset:9216
    ds_read_b64_tr_b16 v[60:61], v12 offset:8192
    ds_read_b64_tr_b16 v[62:63], v12 offset:9216
    s_waitcnt lgkmcnt(5)
    v_mfma_f32_32x32x16_bf16 v[16:31], v[52:55], v[64:67], v[16:31]
    v_mfma_f32_32x32x16_bf16 v[32:47], v[52:55], v[68:71], v[32:47]
    ds_read_b128 v[52:55], v10 offset:0
    ds_read_b64_tr_b16 v[64:65], v11 offset:12288
    ds_read_b64_tr_b16 v[66:67], v11 offset:13312
    ds_read_b64_tr_b16 v[68:69], v12 offset:12288
    ds_read_b64_tr_b16 v[70:71], v12 offset:13312
    s_waitcnt lgkmcnt(5)
    v_mfma_f32_32x32x16_bf16 v[16:31], v[48:51], v[56:59], v[16:31]
    v_mfma_f32_32x32x16_bf16 v[32:47], v[48:51], v[60:63], v[32:47]
    s_waitcnt lgkmcnt(0)
    v_mfma_f32_32x32x16_bf16 v[16:31], v[52:55], v[64:67], v[16:31]
    v_mfma_f32_32x32x16_bf16 v[32:47], v[52:55], v[68:71], v[32:47]
    s_waitcnt vmcnt(0)
    s_barrier
    v_add_u32 v7, 32768, v7
    v_add_u32 v8, 32768, v8
    v_add_u32 v9, 32768, v9
    v_add_u32 v10, 32768, v10
    v_add_u32 v11, 32768, v11
    v_add_u32 v12, 32768, v12
    ds_read_b128 v[48:51], v7 offset:0
    ds_read_b64_tr_b16 v[56:57], v11 offset:0
    ds_read_b64_tr_b16 v[58:59], v11 offset:1024
    ds_read_b64_tr_b16 v[60:61], v12 offset:0
    ds_read_b64_tr_b16 v[62:63], v12 offset:1024
    ds_read_b128 v[52:55], v8 offset:0
    ds_read_b64_tr_b16 v[64:65], v11 offset:4096
    ds_read_b64_tr_b16 v[66:67], v11 offset:5120
    ds_read_b64_tr_b16 v[68:69], v12 offset:4096
    ds_read_b64_tr_b16 v[70:71], v12 offset:5120
    s_waitcnt lgkmcnt(5)
    v_mfma_f32_32x32x16_bf16 v[16:31], v[48:51], v[56:59], v[16:31]
    v_mfma_f32_32x32x16_bf16 v[32:47], v[48:51], v[60:63], v[32:47]
    ds_read_b128 v[48:51], v9 offset:0
    ds_read_b64_tr_b16 v[56:57], v11 offset:8192
    ds_read_b64_tr_b16 v[58:59], v11 offset:9216
    ds_read_b64_tr_b16 v[60:61], v12 offset:8192
    ds_read_b64_tr_b16 v[62:63], v12 offset:9216
    s_waitcnt lgkmcnt(5)
    v_mfma_f32_32x32x16_bf16 v[16:31], v[52:55], v[64:67], v[16:31]
    v_mfma_f32_32x32x16_bf16 v[32:47], v[52:55], v[68:71], v[32:47]
    ds_read_b128 v[52:55], v10 offset:0
    ds_read_b64_tr_b16 v[64:65], v11 offset:12288
    ds_read_b64_tr_b16 v[66:67], v11 offset:13312
    ds_read_b64_tr_b16 v[68:69], v12 offset:12288
    ds_read_b64_tr_b16 v[70:71], v12 offset:13312
    s_waitcnt lgkmcnt(5)
    v_mfma_f32_32x32x16_bf16 v[16:31], v[48:51], v[56:59], v[16:31]
    v_mfma_f32_32x32x16_bf16 v[32:47], v[48:51], v[60:63], v[32:47]
    s_waitcnt lgkmcnt(0)
    v_mfma_f32_32x32x16_bf16 v[16:31], v[52:55], v[64:67], v[16:31]
    v_mfma_f32_32x32x16_bf16 v[32:47], v[52:55], v[68:71], v[32:47]
    v_lshlrev_b32 v2, 12, v13
    v_lshl_add_u32 v2, v14, 4, v2
    s_and_b32 s44, s33, 511
    s_lshl_b32 s43, s44, 12
    s_add_u32 s43, s43, 4194304
    s_lshl_b32 s44, s36, 5
    s_add_u32 s44, s44, s32
    s_lshl_b32 s44, s44, 1
    s_add_u32 s43, s43, s44
    s_lshl_b32 s44, s37, 18
    s_add_u32 s43, s43, s44
    v_cvt_pk_bf16_f32 v4, v16, v17
    v_cvt_pk_bf16_f32 v5, v18, v19
    s_add_u32 s45, s43, 0
    buffer_store_dwordx2 v[4:5], v2, s[28:31], s45 offen offset:0
    v_cvt_pk_bf16_f32 v4, v20, v21
    v_cvt_pk_bf16_f32 v5, v22, v23
    s_add_u32 s45, s43, 0
    buffer_store_dwordx2 v[4:5], v2, s[28:31], s45 offen offset:8
    v_cvt_pk_bf16_f32 v4, v24, v25
    v_cvt_pk_bf16_f32 v5, v26, v27
    s_add_u32 s45, s43, 0
    buffer_store_dwordx2 v[4:5], v2, s[28:31], s45 offen offset:32
    v_cvt_pk_bf16_f32 v4, v28, v29
    v_cvt_pk_bf16_f32 v5, v30, v31
    s_add_u32 s45, s43, 0
    buffer_store_dwordx2 v[4:5], v2, s[28:31], s45 offen offset:40
    v_cvt_pk_bf16_f32 v4, v32, v33
    v_cvt_pk_bf16_f32 v5, v34, v35
    s_add_u32 s45, s43, 131072
    buffer_store_dwordx2 v[4:5], v2, s[28:31], s45 offen offset:0
    v_cvt_pk_bf16_f32 v4, v36, v37
    v_cvt_pk_bf16_f32 v5, v38, v39
    s_add_u32 s45, s43, 131072
    buffer_store_dwordx2 v[4:5], v2, s[28:31], s45 offen offset:8
    v_cvt_pk_bf16_f32 v4, v40, v41
    v_cvt_pk_bf16_f32 v5, v42, v43
    s_add_u32 s45, s43, 131072
    buffer_store_dwordx2 v[4:5], v2, s[28:31], s45 offen offset:32
    v_cvt_pk_bf16_f32 v4, v44, v45
    v_cvt_pk_bf16_f32 v5, v46, v47
    s_add_u32 s45, s43, 131072
    buffer_store_dwordx2 v[4:5], v2, s[28:31], s45 offen offset:40
    s_endpgm
k1_qkv_prep_kernel_prep1:
    s_cmp_ge_u32 s2, 256
    s_cbranch_scc1 k1_qkv_prep_kernel_end2
    s_mov_b32 s36, s10
    s_and_b32 s37, s11, 0xffff
    s_mov_b32 s38, 2097152
    s_mov_b32 s39, 0x00020000
    s_mov_b32 s40, s12
    s_and_b32 s41, s13, 0xffff
    s_mov_b32 s42, 2097152
    s_mov_b32 s43, 0x00020000
    s_mov_b32 s44, s14
    s_and_b32 s45, s15, 0xffff
    s_mov_b32 s46, 4096
    s_mov_b32 s47, 0x00020000
    s_mov_b32 s48, s16
    s_and_b32 s49, s17, 0xffff
    s_mov_b32 s50, 1024
    s_mov_b32 s51, 0x00020000
    s_sub_u32 s52, s2, 192
    s_lshl_b32 s52, s52, 5
    s_lshl_b32 s53, s3, 2
    s_add_u32 s52, s52, s53
    v_lshlrev_b32 v2, 4, v1
    v_lshlrev_b32 v3, 6, v1
    buffer_load_dwordx4 v[64:67], v3, s[44:47], 0 offen offset:0
    buffer_load_dwordx4 v[68:71], v3, s[44:47], 0 offen offset:16
    buffer_load_dwordx4 v[72:75], v3, s[44:47], 0 offen offset:32
    buffer_load_dwordx4 v[76:79], v3, s[44:47], 0 offen offset:48
    buffer_load_dwordx4 v[80:83], v2, s[48:51], 0 offen
    s_lshl_b32 s54, s52, 10
    v_mov_b32 v4, 0
    v_mov_b32 v5, 0
    v_mov_b32 v6, 0
    v_mov_b32 v7, 0
    v_mov_b32 v8, 0
    v_mov_b32 v9, 0
    v_mov_b32 v10, 0
    v_mov_b32 v11, 0
    v_mov_b32 v12, 0
    v_mov_b32 v13, 0
    v_mov_b32 v14, 0
    v_mov_b32 v15, 0
    s_cmp_eq_u32 s52, 0
    s_cbranch_scc1 k1_qkv_prep_kernel_skiphalo4
    s_sub_u32 s53, s54, 3072
    buffer_load_dwordx4 v[4:7], v2, s[36:39], s53 offen offset:0
    buffer_load_dwordx4 v[8:11], v2, s[36:39], s53 offen offset:1024
    buffer_load_dwordx4 v[12:15], v2, s[36:39], s53 offen offset:2048
k1_qkv_prep_kernel_skiphalo4:
    buffer_load_dwordx4 v[16:19], v2, s[36:39], s54 offen offset:0
    buffer_load_dwordx4 v[32:35], v2, s[40:43], s54 offen offset:0
    buffer_load_dwordx4 v[48:51], v2, s[20:23], s54 offen offset:0
    buffer_load_dwordx4 v[20:23], v2, s[36:39], s54 offen offset:1024
    buffer_load_dwordx4 v[36:39], v2, s[40:43], s54 offen offset:1024
    buffer_load_dwordx4 v[52:55], v2, s[20:23], s54 offen offset:1024
    buffer_load_dwordx4 v[24:27], v2, s[36:39], s54 offen offset:2048
    buffer_load_dwordx4 v[40:43], v2, s[40:43], s54 offen offset:2048
    buffer_load_dwordx4 v[56:59], v2, s[20:23], s54 offen offset:2048
    buffer_load_dwordx4 v[28:31], v2, s[36:39], s54 offen offset:3072
    buffer_load_dwordx4 v[44:47], v2, s[40:43], s54 offen offset:3072
    buffer_load_dwordx4 v[60:63], v2, s[20:23], s54 offen offset:3072
    v_lshlrev_b32 v84, 15, v1
    s_lshl_b32 s53, s52, 1
    s_sub_u32 s55, 6295544, s53
    s_waitcnt vmcnt(0)
    v_mov_b32 v109, 0
    v_mov_b32 v110, 0
    v_mov_b32 v111, 0
    v_mov_b32 v112, 0
    v_lshlrev_b32 v85, 16, v4
    v_lshlrev_b32 v86, 16, v8
    v_lshlrev_b32 v87, 16, v12
    v_lshlrev_b32 v88, 16, v16
    v_lshlrev_b32 v89, 16, v20
    v_lshlrev_b32 v90, 16, v24
    v_lshlrev_b32 v91, 16, v28
    v_lshlrev_b32 v92, 16, v32
    v_lshlrev_b32 v93, 16, v36
    v_lshlrev_b32 v94, 16, v40
    v_lshlrev_b32 v95, 16, v44
    v_lshlrev_b32 v96, 16, v64
    v_and_b32 v97, 0xffff0000, v64
    v_lshlrev_b32 v98, 16, v65
    v_and_b32 v99, 0xffff0000, v65
    v_mul_f32 v100, v85, v99
    v_mul_f32 v101, v86, v99
    v_mul_f32 v102, v87, v99
    v_mul_f32 v103, v88, v99
    v_cvt_pk_bf16_f32 v108, v100, v101
    v_lshlrev_b32 v100, 16, v108
    v_and_b32 v101, 0xffff0000, v108
    v_cvt_pk_bf16_f32 v108, v102, v103
    v_lshlrev_b32 v102, 16, v108
    v_and_b32 v103, 0xffff0000, v108
    v_mul_f32 v104, v86, v98
    v_mul_f32 v105, v87, v98
    v_mul_f32 v106, v88, v98
    v_mul_f32 v107, v89, v98
    v_cvt_pk_bf16_f32 v108, v104, v105
    v_lshlrev_b32 v104, 16, v108
    v_and_b32 v105, 0xffff0000, v108
    v_cvt_pk_bf16_f32 v108, v106, v107
    v_lshlrev_b32 v106, 16, v108
    v_and_b32 v107, 0xffff0000, v108
    v_add_f32 v100, v100, v104
    v_add_f32 v101, v101, v105
    v_add_f32 v102, v102, v106
    v_add_f32 v103, v103, v107
    v_cvt_pk_bf16_f32 v108, v100, v101
    v_lshlrev_b32 v100, 16, v108
    v_and_b32 v101, 0xffff0000, v108
    v_cvt_pk_bf16_f32 v108, v102, v103
    v_lshlrev_b32 v102, 16, v108
    v_and_b32 v103, 0xffff0000, v108
    v_mul_f32 v104, v87, v97
    v_mul_f32 v105, v88, v97
    v_mul_f32 v106, v89, v97
    v_mul_f32 v107, v90, v97
    v_cvt_pk_bf16_f32 v108, v104, v105
    v_lshlrev_b32 v104, 16, v108
    v_and_b32 v105, 0xffff0000, v108
    v_cvt_pk_bf16_f32 v108, v106, v107
    v_lshlrev_b32 v106, 16, v108
    v_and_b32 v107, 0xffff0000, v108
    v_add_f32 v100, v100, v104
    v_add_f32 v101, v101, v105
    v_add_f32 v102, v102, v106
    v_add_f32 v103, v103, v107
    v_cvt_pk_bf16_f32 v108, v100, v101
    v_lshlrev_b32 v100, 16, v108
    v_and_b32 v101, 0xffff0000, v108
    v_cvt_pk_bf16_f32 v108, v102, v103
    v_lshlrev_b32 v102, 16, v108
    v_and_b32 v103, 0xffff0000, v108
    v_mul_f32 v104, v88, v96
    v_mul_f32 v105, v89, v96
    v_mul_f32 v106, v90, v96
    v_mul_f32 v107, v91, v96
    v_cvt_pk_bf16_f32 v108, v104, v105
    v_lshlrev_b32 v104, 16, v108
    v_and_b32 v105, 0xffff0000, v108
    v_cvt_pk_bf16_f32 v108, v106, v107
    v_lshlrev_b32 v106, 16, v108
    v_and_b32 v107, 0xffff0000, v108
    v_add_f32 v100, v100, v104
    v_add_f32 v101, v101, v105
    v_add_f32 v102, v102, v106
    v_add_f32 v103, v103, v107
    v_cvt_pk_bf16_f32 v108, v100, v101
    v_lshlrev_b32 v100, 16, v108
    v_and_b32 v101, 0xffff0000, v108
    v_cvt_pk_bf16_f32 v108, v102, v103
    v_lshlrev_b32 v102, 16, v108
    v_and_b32 v103, 0xffff0000, v108
    v_mul_f32 v100, v100, v92
    v_mul_f32 v101, v101, v93
    v_mul_f32 v102, v102, v94
    v_mul_f32 v103, v103, v95
    v_cvt_pk_bf16_f32 v118, v103, v102
    v_cvt_pk_bf16_f32 v119, v101, v100
    s_add_u32 s53, s55, 0
    buffer_store_dwordx2 v[118:119], v84, s[28:31], s53 offen
    v_lshlrev_b32 v117, 16, v80
    v_lshlrev_b32 v113, 16, v48
    v_mul_f32 v113, v113, v117
    v_lshlrev_b32 v114, 16, v52
    v_mul_f32 v114, v114, v117
    v_lshlrev_b32 v115, 16, v56
    v_mul_f32 v115, v115, v117
    v_lshlrev_b32 v116, 16, v60
    v_mul_f32 v116, v116, v117
    v_cvt_pk_bf16_f32 v108, v113, v114
    v_lshlrev_b32 v113, 16, v108
    v_and_b32 v114, 0xffff0000, v108
    v_cvt_pk_bf16_f32 v108, v115, v116
    v_lshlrev_b32 v115, 16, v108
    v_and_b32 v116, 0xffff0000, v108
    v_add_f32 v109, v109, v113
    v_add_f32 v110, v110, v114
    v_add_f32 v111, v111, v115
    v_add_f32 v112, v112, v116
    v_and_b32 v85, 0xffff0000, v4
    v_and_b32 v86, 0xffff0000, v8
    v_and_b32 v87, 0xffff0000, v12
    v_and_b32 v88, 0xffff0000, v16
    v_and_b32 v89, 0xffff0000, v20
    v_and_b32 v90, 0xffff0000, v24
    v_and_b32 v91, 0xffff0000, v28
    v_and_b32 v92, 0xffff0000, v32
    v_and_b32 v93, 0xffff0000, v36
    v_and_b32 v94, 0xffff0000, v40
    v_and_b32 v95, 0xffff0000, v44
    v_lshlrev_b32 v96, 16, v66
    v_and_b32 v97, 0xffff0000, v66
    v_lshlrev_b32 v98, 16, v67
    v_and_b32 v99, 0xffff0000, v67
    v_mul_f32 v100, v85, v99
    v_mul_f32 v101, v86, v99
    v_mul_f32 v102, v87, v99
    v_mul_f32 v103, v88, v99
    v_cvt_pk_bf16_f32 v108, v100, v101
    v_lshlrev_b32 v100, 16, v108
    v_and_b32 v101, 0xffff0000, v108
    v_cvt_pk_bf16_f32 v108, v102, v103
    v_lshlrev_b32 v102, 16, v108
    v_and_b32 v103, 0xffff0000, v108
    v_mul_f32 v104, v86, v98
    v_mul_f32 v105, v87, v98
    v_mul_f32 v106, v88, v98
    v_mul_f32 v107, v89, v98
    v_cvt_pk_bf16_f32 v108, v104, v105
    v_lshlrev_b32 v104, 16, v108
    v_and_b32 v105, 0xffff0000, v108
    v_cvt_pk_bf16_f32 v108, v106, v107
    v_lshlrev_b32 v106, 16, v108
    v_and_b32 v107, 0xffff0000, v108
    v_add_f32 v100, v100, v104
    v_add_f32 v101, v101, v105
    v_add_f32 v102, v102, v106
    v_add_f32 v103, v103, v107
    v_cvt_pk_bf16_f32 v108, v100, v101
    v_lshlrev_b32 v100, 16, v108
    v_and_b32 v101, 0xffff0000, v108
    v_cvt_pk_bf16_f32 v108, v102, v103
    v_lshlrev_b32 v102, 16, v108
    v_and_b32 v103, 0xffff0000, v108
    v_mul_f32 v104, v87, v97
    v_mul_f32 v105, v88, v97
    v_mul_f32 v106, v89, v97
    v_mul_f32 v107, v90, v97
    v_cvt_pk_bf16_f32 v108, v104, v105
    v_lshlrev_b32 v104, 16, v108
    v_and_b32 v105, 0xffff0000, v108
    v_cvt_pk_bf16_f32 v108, v106, v107
    v_lshlrev_b32 v106, 16, v108
    v_and_b32 v107, 0xffff0000, v108
    v_add_f32 v100, v100, v104
    v_add_f32 v101, v101, v105
    v_add_f32 v102, v102, v106
    v_add_f32 v103, v103, v107
    v_cvt_pk_bf16_f32 v108, v100, v101
    v_lshlrev_b32 v100, 16, v108
    v_and_b32 v101, 0xffff0000, v108
    v_cvt_pk_bf16_f32 v108, v102, v103
    v_lshlrev_b32 v102, 16, v108
    v_and_b32 v103, 0xffff0000, v108
    v_mul_f32 v104, v88, v96
    v_mul_f32 v105, v89, v96
    v_mul_f32 v106, v90, v96
    v_mul_f32 v107, v91, v96
    v_cvt_pk_bf16_f32 v108, v104, v105
    v_lshlrev_b32 v104, 16, v108
    v_and_b32 v105, 0xffff0000, v108
    v_cvt_pk_bf16_f32 v108, v106, v107
    v_lshlrev_b32 v106, 16, v108
    v_and_b32 v107, 0xffff0000, v108
    v_add_f32 v100, v100, v104
    v_add_f32 v101, v101, v105
    v_add_f32 v102, v102, v106
    v_add_f32 v103, v103, v107
    v_cvt_pk_bf16_f32 v108, v100, v101
    v_lshlrev_b32 v100, 16, v108
    v_and_b32 v101, 0xffff0000, v108
    v_cvt_pk_bf16_f32 v108, v102, v103
    v_lshlrev_b32 v102, 16, v108
    v_and_b32 v103, 0xffff0000, v108
    v_mul_f32 v100, v100, v92
    v_mul_f32 v101, v101, v93
    v_mul_f32 v102, v102, v94
    v_mul_f32 v103, v103, v95
    v_cvt_pk_bf16_f32 v118, v103, v102
    v_cvt_pk_bf16_f32 v119, v101, v100
    s_add_u32 s53, s55, 4096
    buffer_store_dwordx2 v[118:119], v84, s[28:31], s53 offen
    v_and_b32 v117, 0xffff0000, v80
    v_and_b32 v113, 0xffff0000, v48
    v_mul_f32 v113, v113, v117
    v_and_b32 v114, 0xffff0000, v52
    v_mul_f32 v114, v114, v117
    v_and_b32 v115, 0xffff0000, v56
    v_mul_f32 v115, v115, v117
    v_and_b32 v116, 0xffff0000, v60
    v_mul_f32 v116, v116, v117
    v_cvt_pk_bf16_f32 v108, v113, v114
    v_lshlrev_b32 v113, 16, v108
    v_and_b32 v114, 0xffff0000, v108
    v_cvt_pk_bf16_f32 v108, v115, v116
    v_lshlrev_b32 v115, 16, v108
    v_and_b32 v116, 0xffff0000, v108
    v_add_f32 v109, v109, v113
    v_add_f32 v110, v110, v114
    v_add_f32 v111, v111, v115
    v_add_f32 v112, v112, v116
    v_lshlrev_b32 v85, 16, v5
    v_lshlrev_b32 v86, 16, v9
    v_lshlrev_b32 v87, 16, v13
    v_lshlrev_b32 v88, 16, v17
    v_lshlrev_b32 v89, 16, v21
    v_lshlrev_b32 v90, 16, v25
    v_lshlrev_b32 v91, 16, v29
    v_lshlrev_b32 v92, 16, v33
    v_lshlrev_b32 v93, 16, v37
    v_lshlrev_b32 v94, 16, v41
    v_lshlrev_b32 v95, 16, v45
    v_lshlrev_b32 v96, 16, v68
    v_and_b32 v97, 0xffff0000, v68
    v_lshlrev_b32 v98, 16, v69
    v_and_b32 v99, 0xffff0000, v69
    v_mul_f32 v100, v85, v99
    v_mul_f32 v101, v86, v99
    v_mul_f32 v102, v87, v99
    v_mul_f32 v103, v88, v99
    v_cvt_pk_bf16_f32 v108, v100, v101
    v_lshlrev_b32 v100, 16, v108
    v_and_b32 v101, 0xffff0000, v108
    v_cvt_pk_bf16_f32 v108, v102, v103
    v_lshlrev_b32 v102, 16, v108
    v_and_b32 v103, 0xffff0000, v108
    v_mul_f32 v104, v86, v98
    v_mul_f32 v105, v87, v98
    v_mul_f32 v106, v88, v98
    v_mul_f32 v107, v89, v98
    v_cvt_pk_bf16_f32 v108, v104, v105
    v_lshlrev_b32 v104, 16, v108
    v_and_b32 v105, 0xffff0000, v108
    v_cvt_pk_bf16_f32 v108, v106, v107
    v_lshlrev_b32 v106, 16, v108
    v_and_b32 v107, 0xffff0000, v108
    v_add_f32 v100, v100, v104
    v_add_f32 v101, v101, v105
    v_add_f32 v102, v102, v106
    v_add_f32 v103, v103, v107
    v_cvt_pk_bf16_f32 v108, v100, v101
    v_lshlrev_b32 v100, 16, v108
    v_and_b32 v101, 0xffff0000, v108
    v_cvt_pk_bf16_f32 v108, v102, v103
    v_lshlrev_b32 v102, 16, v108
    v_and_b32 v103, 0xffff0000, v108
    v_mul_f32 v104, v87, v97
    v_mul_f32 v105, v88, v97
    v_mul_f32 v106, v89, v97
    v_mul_f32 v107, v90, v97
    v_cvt_pk_bf16_f32 v108, v104, v105
    v_lshlrev_b32 v104, 16, v108
    v_and_b32 v105, 0xffff0000, v108
    v_cvt_pk_bf16_f32 v108, v106, v107
    v_lshlrev_b32 v106, 16, v108
    v_and_b32 v107, 0xffff0000, v108
    v_add_f32 v100, v100, v104
    v_add_f32 v101, v101, v105
    v_add_f32 v102, v102, v106
    v_add_f32 v103, v103, v107
    v_cvt_pk_bf16_f32 v108, v100, v101
    v_lshlrev_b32 v100, 16, v108
    v_and_b32 v101, 0xffff0000, v108
    v_cvt_pk_bf16_f32 v108, v102, v103
    v_lshlrev_b32 v102, 16, v108
    v_and_b32 v103, 0xffff0000, v108
    v_mul_f32 v104, v88, v96
    v_mul_f32 v105, v89, v96
    v_mul_f32 v106, v90, v96
    v_mul_f32 v107, v91, v96
    v_cvt_pk_bf16_f32 v108, v104, v105
    v_lshlrev_b32 v104, 16, v108
    v_and_b32 v105, 0xffff0000, v108
    v_cvt_pk_bf16_f32 v108, v106, v107
    v_lshlrev_b32 v106, 16, v108
    v_and_b32 v107, 0xffff0000, v108
    v_add_f32 v100, v100, v104
    v_add_f32 v101, v101, v105
    v_add_f32 v102, v102, v106
    v_add_f32 v103, v103, v107
    v_cvt_pk_bf16_f32 v108, v100, v101
    v_lshlrev_b32 v100, 16, v108
    v_and_b32 v101, 0xffff0000, v108
    v_cvt_pk_bf16_f32 v108, v102, v103
    v_lshlrev_b32 v102, 16, v108
    v_and_b32 v103, 0xffff0000, v108
    v_mul_f32 v100, v100, v92
    v_mul_f32 v101, v101, v93
    v_mul_f32 v102, v102, v94
    v_mul_f32 v103, v103, v95
    v_cvt_pk_bf16_f32 v118, v103, v102
    v_cvt_pk_bf16_f32 v119, v101, v100
    s_add_u32 s53, s55, 8192
    buffer_store_dwordx2 v[118:119], v84, s[28:31], s53 offen
    v_lshlrev_b32 v117, 16, v81
    v_lshlrev_b32 v113, 16, v49
    v_mul_f32 v113, v113, v117
    v_lshlrev_b32 v114, 16, v53
    v_mul_f32 v114, v114, v117
    v_lshlrev_b32 v115, 16, v57
    v_mul_f32 v115, v115, v117
    v_lshlrev_b32 v116, 16, v61
    v_mul_f32 v116, v116, v117
    v_cvt_pk_bf16_f32 v108, v113, v114
    v_lshlrev_b32 v113, 16, v108
    v_and_b32 v114, 0xffff0000, v108
    v_cvt_pk_bf16_f32 v108, v115, v116
    v_lshlrev_b32 v115, 16, v108
    v_and_b32 v116, 0xffff0000, v108
    v_add_f32 v109, v109, v113
    v_add_f32 v110, v110, v114
    v_add_f32 v111, v111, v115
    v_add_f32 v112, v112, v116
    v_and_b32 v85, 0xffff0000, v5
    v_and_b32 v86, 0xffff0000, v9
    v_and_b32 v87, 0xffff0000, v13
    v_and_b32 v88, 0xffff0000, v17
    v_and_b32 v89, 0xffff0000, v21
    v_and_b32 v90, 0xffff0000, v25
    v_and_b32 v91, 0xffff0000, v29
    v_and_b32 v92, 0xffff0000, v33
    v_and_b32 v93, 0xffff0000, v37
    v_and_b32 v94, 0xffff0000, v41
    v_and_b32 v95, 0xffff0000, v45
    v_lshlrev_b32 v96, 16, v70
    v_and_b32 v97, 0xffff0000, v70
    v_lshlrev_b32 v98, 16, v71
    v_and_b32 v99, 0xffff0000, v71
    v_mul_f32 v100, v85, v99
    v_mul_f32 v101, v86, v99
    v_mul_f32 v102, v87, v99
    v_mul_f32 v103, v88, v99
    v_cvt_pk_bf16_f32 v108, v100, v101
    v_lshlrev_b32 v100, 16, v108
    v_and_b32 v101, 0xffff0000, v108
    v_cvt_pk_bf16_f32 v108, v102, v103
    v_lshlrev_b32 v102, 16, v108
    v_and_b32 v103, 0xffff0000, v108
    v_mul_f32 v104, v86, v98
    v_mul_f32 v105, v87, v98
    v_mul_f32 v106, v88, v98
    v_mul_f32 v107, v89, v98
    v_cvt_pk_bf16_f32 v108, v104, v105
    v_lshlrev_b32 v104, 16, v108
    v_and_b32 v105, 0xffff0000, v108
    v_cvt_pk_bf16_f32 v108, v106, v107
    v_lshlrev_b32 v106, 16, v108
    v_and_b32 v107, 0xffff0000, v108
    v_add_f32 v100, v100, v104
    v_add_f32 v101, v101, v105
    v_add_f32 v102, v102, v106
    v_add_f32 v103, v103, v107
    v_cvt_pk_bf16_f32 v108, v100, v101
    v_lshlrev_b32 v100, 16, v108
    v_and_b32 v101, 0xffff0000, v108
    v_cvt_pk_bf16_f32 v108, v102, v103
    v_lshlrev_b32 v102, 16, v108
    v_and_b32 v103, 0xffff0000, v108
    v_mul_f32 v104, v87, v97
    v_mul_f32 v105, v88, v97
    v_mul_f32 v106, v89, v97
    v_mul_f32 v107, v90, v97
    v_cvt_pk_bf16_f32 v108, v104, v105
    v_lshlrev_b32 v104, 16, v108
    v_and_b32 v105, 0xffff0000, v108
    v_cvt_pk_bf16_f32 v108, v106, v107
    v_lshlrev_b32 v106, 16, v108
    v_and_b32 v107, 0xffff0000, v108
    v_add_f32 v100, v100, v104
    v_add_f32 v101, v101, v105
    v_add_f32 v102, v102, v106
    v_add_f32 v103, v103, v107
    v_cvt_pk_bf16_f32 v108, v100, v101
    v_lshlrev_b32 v100, 16, v108
    v_and_b32 v101, 0xffff0000, v108
    v_cvt_pk_bf16_f32 v108, v102, v103
    v_lshlrev_b32 v102, 16, v108
    v_and_b32 v103, 0xffff0000, v108
    v_mul_f32 v104, v88, v96
    v_mul_f32 v105, v89, v96
    v_mul_f32 v106, v90, v96
    v_mul_f32 v107, v91, v96
    v_cvt_pk_bf16_f32 v108, v104, v105
    v_lshlrev_b32 v104, 16, v108
    v_and_b32 v105, 0xffff0000, v108
    v_cvt_pk_bf16_f32 v108, v106, v107
    v_lshlrev_b32 v106, 16, v108
    v_and_b32 v107, 0xffff0000, v108
    v_add_f32 v100, v100, v104
    v_add_f32 v101, v101, v105
    v_add_f32 v102, v102, v106
    v_add_f32 v103, v103, v107
    v_cvt_pk_bf16_f32 v108, v100, v101
    v_lshlrev_b32 v100, 16, v108
    v_and_b32 v101, 0xffff0000, v108
    v_cvt_pk_bf16_f32 v108, v102, v103
    v_lshlrev_b32 v102, 16, v108
    v_and_b32 v103, 0xffff0000, v108
    v_mul_f32 v100, v100, v92
    v_mul_f32 v101, v101, v93
    v_mul_f32 v102, v102, v94
    v_mul_f32 v103, v103, v95
    v_cvt_pk_bf16_f32 v118, v103, v102
    v_cvt_pk_bf16_f32 v119, v101, v100
    s_add_u32 s53, s55, 12288
    buffer_store_dwordx2 v[118:119], v84, s[28:31], s53 offen
    v_and_b32 v117, 0xffff0000, v81
    v_and_b32 v113, 0xffff0000, v49
    v_mul_f32 v113, v113, v117
    v_and_b32 v114, 0xffff0000, v53
    v_mul_f32 v114, v114, v117
    v_and_b32 v115, 0xffff0000, v57
    v_mul_f32 v115, v115, v117
    v_and_b32 v116, 0xffff0000, v61
    v_mul_f32 v116, v116, v117
    v_cvt_pk_bf16_f32 v108, v113, v114
    v_lshlrev_b32 v113, 16, v108
    v_and_b32 v114, 0xffff0000, v108
    v_cvt_pk_bf16_f32 v108, v115, v116
    v_lshlrev_b32 v115, 16, v108
    v_and_b32 v116, 0xffff0000, v108
    v_add_f32 v109, v109, v113
    v_add_f32 v110, v110, v114
    v_add_f32 v111, v111, v115
    v_add_f32 v112, v112, v116
    v_lshlrev_b32 v85, 16, v6
    v_lshlrev_b32 v86, 16, v10
    v_lshlrev_b32 v87, 16, v14
    v_lshlrev_b32 v88, 16, v18
    v_lshlrev_b32 v89, 16, v22
    v_lshlrev_b32 v90, 16, v26
    v_lshlrev_b32 v91, 16, v30
    v_lshlrev_b32 v92, 16, v34
    v_lshlrev_b32 v93, 16, v38
    v_lshlrev_b32 v94, 16, v42
    v_lshlrev_b32 v95, 16, v46
    v_lshlrev_b32 v96, 16, v72
    v_and_b32 v97, 0xffff0000, v72
    v_lshlrev_b32 v98, 16, v73
    v_and_b32 v99, 0xffff0000, v73
    v_mul_f32 v100, v85, v99
    v_mul_f32 v101, v86, v99
    v_mul_f32 v102, v87, v99
    v_mul_f32 v103, v88, v99
    v_cvt_pk_bf16_f32 v108, v100, v101
    v_lshlrev_b32 v100, 16, v108
    v_and_b32 v101, 0xffff0000, v108
    v_cvt_pk_bf16_f32 v108, v102, v103
    v_lshlrev_b32 v102, 16, v108
    v_and_b32 v103, 0xffff0000, v108
    v_mul_f32 v104, v86, v98
    v_mul_f32 v105, v87, v98
    v_mul_f32 v106, v88, v98
    v_mul_f32 v107, v89, v98
    v_cvt_pk_bf16_f32 v108, v104, v105
    v_lshlrev_b32 v104, 16, v108
    v_and_b32 v105, 0xffff0000, v108
    v_cvt_pk_bf16_f32 v108, v106, v107
    v_lshlrev_b32 v106, 16, v108
    v_and_b32 v107, 0xffff0000, v108
    v_add_f32 v100, v100, v104
    v_add_f32 v101, v101, v105
    v_add_f32 v102, v102, v106
    v_add_f32 v103, v103, v107
    v_cvt_pk_bf16_f32 v108, v100, v101
    v_lshlrev_b32 v100, 16, v108
    v_and_b32 v101, 0xffff0000, v108
    v_cvt_pk_bf16_f32 v108, v102, v103
    v_lshlrev_b32 v102, 16, v108
    v_and_b32 v103, 0xffff0000, v108
    v_mul_f32 v104, v87, v97
    v_mul_f32 v105, v88, v97
    v_mul_f32 v106, v89, v97
    v_mul_f32 v107, v90, v97
    v_cvt_pk_bf16_f32 v108, v104, v105
    v_lshlrev_b32 v104, 16, v108
    v_and_b32 v105, 0xffff0000, v108
    v_cvt_pk_bf16_f32 v108, v106, v107
    v_lshlrev_b32 v106, 16, v108
    v_and_b32 v107, 0xffff0000, v108
    v_add_f32 v100, v100, v104
    v_add_f32 v101, v101, v105
    v_add_f32 v102, v102, v106
    v_add_f32 v103, v103, v107
    v_cvt_pk_bf16_f32 v108, v100, v101
    v_lshlrev_b32 v100, 16, v108
    v_and_b32 v101, 0xffff0000, v108
    v_cvt_pk_bf16_f32 v108, v102, v103
    v_lshlrev_b32 v102, 16, v108
    v_and_b32 v103, 0xffff0000, v108
    v_mul_f32 v104, v88, v96
    v_mul_f32 v105, v89, v96
    v_mul_f32 v106, v90, v96
    v_mul_f32 v107, v91, v96
    v_cvt_pk_bf16_f32 v108, v104, v105
    v_lshlrev_b32 v104, 16, v108
    v_and_b32 v105, 0xffff0000, v108
    v_cvt_pk_bf16_f32 v108, v106, v107
    v_lshlrev_b32 v106, 16, v108
    v_and_b32 v107, 0xffff0000, v108
    v_add_f32 v100, v100, v104
    v_add_f32 v101, v101, v105
    v_add_f32 v102, v102, v106
    v_add_f32 v103, v103, v107
    v_cvt_pk_bf16_f32 v108, v100, v101
    v_lshlrev_b32 v100, 16, v108
    v_and_b32 v101, 0xffff0000, v108
    v_cvt_pk_bf16_f32 v108, v102, v103
    v_lshlrev_b32 v102, 16, v108
    v_and_b32 v103, 0xffff0000, v108
    v_mul_f32 v100, v100, v92
    v_mul_f32 v101, v101, v93
    v_mul_f32 v102, v102, v94
    v_mul_f32 v103, v103, v95
    v_cvt_pk_bf16_f32 v118, v103, v102
    v_cvt_pk_bf16_f32 v119, v101, v100
    s_add_u32 s53, s55, 16384
    buffer_store_dwordx2 v[118:119], v84, s[28:31], s53 offen
    v_lshlrev_b32 v117, 16, v82
    v_lshlrev_b32 v113, 16, v50
    v_mul_f32 v113, v113, v117
    v_lshlrev_b32 v114, 16, v54
    v_mul_f32 v114, v114, v117
    v_lshlrev_b32 v115, 16, v58
    v_mul_f32 v115, v115, v117
    v_lshlrev_b32 v116, 16, v62
    v_mul_f32 v116, v116, v117
    v_cvt_pk_bf16_f32 v108, v113, v114
    v_lshlrev_b32 v113, 16, v108
    v_and_b32 v114, 0xffff0000, v108
    v_cvt_pk_bf16_f32 v108, v115, v116
    v_lshlrev_b32 v115, 16, v108
    v_and_b32 v116, 0xffff0000, v108
    v_add_f32 v109, v109, v113
    v_add_f32 v110, v110, v114
    v_add_f32 v111, v111, v115
    v_add_f32 v112, v112, v116
    v_and_b32 v85, 0xffff0000, v6
    v_and_b32 v86, 0xffff0000, v10
    v_and_b32 v87, 0xffff0000, v14
    v_and_b32 v88, 0xffff0000, v18
    v_and_b32 v89, 0xffff0000, v22
    v_and_b32 v90, 0xffff0000, v26
    v_and_b32 v91, 0xffff0000, v30
    v_and_b32 v92, 0xffff0000, v34
    v_and_b32 v93, 0xffff0000, v38
    v_and_b32 v94, 0xffff0000, v42
    v_and_b32 v95, 0xffff0000, v46
    v_lshlrev_b32 v96, 16, v74
    v_and_b32 v97, 0xffff0000, v74
    v_lshlrev_b32 v98, 16, v75
    v_and_b32 v99, 0xffff0000, v75
    v_mul_f32 v100, v85, v99
    v_mul_f32 v101, v86, v99
    v_mul_f32 v102, v87, v99
    v_mul_f32 v103, v88, v99
    v_cvt_pk_bf16_f32 v108, v100, v101
    v_lshlrev_b32 v100, 16, v108
    v_and_b32 v101, 0xffff0000, v108
    v_cvt_pk_bf16_f32 v108, v102, v103
    v_lshlrev_b32 v102, 16, v108
    v_and_b32 v103, 0xffff0000, v108
    v_mul_f32 v104, v86, v98
    v_mul_f32 v105, v87, v98
    v_mul_f32 v106, v88, v98
    v_mul_f32 v107, v89, v98
    v_cvt_pk_bf16_f32 v108, v104, v105
    v_lshlrev_b32 v104, 16, v108
    v_and_b32 v105, 0xffff0000, v108
    v_cvt_pk_bf16_f32 v108, v106, v107
    v_lshlrev_b32 v106, 16, v108
    v_and_b32 v107, 0xffff0000, v108
    v_add_f32 v100, v100, v104
    v_add_f32 v101, v101, v105
    v_add_f32 v102, v102, v106
    v_add_f32 v103, v103, v107
    v_cvt_pk_bf16_f32 v108, v100, v101
    v_lshlrev_b32 v100, 16, v108
    v_and_b32 v101, 0xffff0000, v108
    v_cvt_pk_bf16_f32 v108, v102, v103
    v_lshlrev_b32 v102, 16, v108
    v_and_b32 v103, 0xffff0000, v108
    v_mul_f32 v104, v87, v97
    v_mul_f32 v105, v88, v97
    v_mul_f32 v106, v89, v97
    v_mul_f32 v107, v90, v97
    v_cvt_pk_bf16_f32 v108, v104, v105
    v_lshlrev_b32 v104, 16, v108
    v_and_b32 v105, 0xffff0000, v108
    v_cvt_pk_bf16_f32 v108, v106, v107
    v_lshlrev_b32 v106, 16, v108
    v_and_b32 v107, 0xffff0000, v108
    v_add_f32 v100, v100, v104
    v_add_f32 v101, v101, v105
    v_add_f32 v102, v102, v106
    v_add_f32 v103, v103, v107
    v_cvt_pk_bf16_f32 v108, v100, v101
    v_lshlrev_b32 v100, 16, v108
    v_and_b32 v101, 0xffff0000, v108
    v_cvt_pk_bf16_f32 v108, v102, v103
    v_lshlrev_b32 v102, 16, v108
    v_and_b32 v103, 0xffff0000, v108
    v_mul_f32 v104, v88, v96
    v_mul_f32 v105, v89, v96
    v_mul_f32 v106, v90, v96
    v_mul_f32 v107, v91, v96
    v_cvt_pk_bf16_f32 v108, v104, v105
    v_lshlrev_b32 v104, 16, v108
    v_and_b32 v105, 0xffff0000, v108
    v_cvt_pk_bf16_f32 v108, v106, v107
    v_lshlrev_b32 v106, 16, v108
    v_and_b32 v107, 0xffff0000, v108
    v_add_f32 v100, v100, v104
    v_add_f32 v101, v101, v105
    v_add_f32 v102, v102, v106
    v_add_f32 v103, v103, v107
    v_cvt_pk_bf16_f32 v108, v100, v101
    v_lshlrev_b32 v100, 16, v108
    v_and_b32 v101, 0xffff0000, v108
    v_cvt_pk_bf16_f32 v108, v102, v103
    v_lshlrev_b32 v102, 16, v108
    v_and_b32 v103, 0xffff0000, v108
    v_mul_f32 v100, v100, v92
    v_mul_f32 v101, v101, v93
    v_mul_f32 v102, v102, v94
    v_mul_f32 v103, v103, v95
    v_cvt_pk_bf16_f32 v118, v103, v102
    v_cvt_pk_bf16_f32 v119, v101, v100
    s_add_u32 s53, s55, 20480
    buffer_store_dwordx2 v[118:119], v84, s[28:31], s53 offen
    v_and_b32 v117, 0xffff0000, v82
    v_and_b32 v113, 0xffff0000, v50
    v_mul_f32 v113, v113, v117
    v_and_b32 v114, 0xffff0000, v54
    v_mul_f32 v114, v114, v117
    v_and_b32 v115, 0xffff0000, v58
    v_mul_f32 v115, v115, v117
    v_and_b32 v116, 0xffff0000, v62
    v_mul_f32 v116, v116, v117
    v_cvt_pk_bf16_f32 v108, v113, v114
    v_lshlrev_b32 v113, 16, v108
    v_and_b32 v114, 0xffff0000, v108
    v_cvt_pk_bf16_f32 v108, v115, v116
    v_lshlrev_b32 v115, 16, v108
    v_and_b32 v116, 0xffff0000, v108
    v_add_f32 v109, v109, v113
    v_add_f32 v110, v110, v114
    v_add_f32 v111, v111, v115
    v_add_f32 v112, v112, v116
    v_lshlrev_b32 v85, 16, v7
    v_lshlrev_b32 v86, 16, v11
    v_lshlrev_b32 v87, 16, v15
    v_lshlrev_b32 v88, 16, v19
    v_lshlrev_b32 v89, 16, v23
    v_lshlrev_b32 v90, 16, v27
    v_lshlrev_b32 v91, 16, v31
    v_lshlrev_b32 v92, 16, v35
    v_lshlrev_b32 v93, 16, v39
    v_lshlrev_b32 v94, 16, v43
    v_lshlrev_b32 v95, 16, v47
    v_lshlrev_b32 v96, 16, v76
    v_and_b32 v97, 0xffff0000, v76
    v_lshlrev_b32 v98, 16, v77
    v_and_b32 v99, 0xffff0000, v77
    v_mul_f32 v100, v85, v99
    v_mul_f32 v101, v86, v99
    v_mul_f32 v102, v87, v99
    v_mul_f32 v103, v88, v99
    v_cvt_pk_bf16_f32 v108, v100, v101
    v_lshlrev_b32 v100, 16, v108
    v_and_b32 v101, 0xffff0000, v108
    v_cvt_pk_bf16_f32 v108, v102, v103
    v_lshlrev_b32 v102, 16, v108
    v_and_b32 v103, 0xffff0000, v108
    v_mul_f32 v104, v86, v98
    v_mul_f32 v105, v87, v98
    v_mul_f32 v106, v88, v98
    v_mul_f32 v107, v89, v98
    v_cvt_pk_bf16_f32 v108, v104, v105
    v_lshlrev_b32 v104, 16, v108
    v_and_b32 v105, 0xffff0000, v108
    v_cvt_pk_bf16_f32 v108, v106, v107
    v_lshlrev_b32 v106, 16, v108
    v_and_b32 v107, 0xffff0000, v108
    v_add_f32 v100, v100, v104
    v_add_f32 v101, v101, v105
    v_add_f32 v102, v102, v106
    v_add_f32 v103, v103, v107
    v_cvt_pk_bf16_f32 v108, v100, v101
    v_lshlrev_b32 v100, 16, v108
    v_and_b32 v101, 0xffff0000, v108
    v_cvt_pk_bf16_f32 v108, v102, v103
    v_lshlrev_b32 v102, 16, v108
    v_and_b32 v103, 0xffff0000, v108
    v_mul_f32 v104, v87, v97
    v_mul_f32 v105, v88, v97
    v_mul_f32 v106, v89, v97
    v_mul_f32 v107, v90, v97
    v_cvt_pk_bf16_f32 v108, v104, v105
    v_lshlrev_b32 v104, 16, v108
    v_and_b32 v105, 0xffff0000, v108
    v_cvt_pk_bf16_f32 v108, v106, v107
    v_lshlrev_b32 v106, 16, v108
    v_and_b32 v107, 0xffff0000, v108
    v_add_f32 v100, v100, v104
    v_add_f32 v101, v101, v105
    v_add_f32 v102, v102, v106
    v_add_f32 v103, v103, v107
    v_cvt_pk_bf16_f32 v108, v100, v101
    v_lshlrev_b32 v100, 16, v108
    v_and_b32 v101, 0xffff0000, v108
    v_cvt_pk_bf16_f32 v108, v102, v103
    v_lshlrev_b32 v102, 16, v108
    v_and_b32 v103, 0xffff0000, v108
    v_mul_f32 v104, v88, v96
    v_mul_f32 v105, v89, v96
    v_mul_f32 v106, v90, v96
    v_mul_f32 v107, v91, v96
    v_cvt_pk_bf16_f32 v108, v104, v105
    v_lshlrev_b32 v104, 16, v108
    v_and_b32 v105, 0xffff0000, v108
    v_cvt_pk_bf16_f32 v108, v106, v107
    v_lshlrev_b32 v106, 16, v108
    v_and_b32 v107, 0xffff0000, v108
    v_add_f32 v100, v100, v104
    v_add_f32 v101, v101, v105
    v_add_f32 v102, v102, v106
    v_add_f32 v103, v103, v107
    v_cvt_pk_bf16_f32 v108, v100, v101
    v_lshlrev_b32 v100, 16, v108
    v_and_b32 v101, 0xffff0000, v108
    v_cvt_pk_bf16_f32 v108, v102, v103
    v_lshlrev_b32 v102, 16, v108
    v_and_b32 v103, 0xffff0000, v108
    v_mul_f32 v100, v100, v92
    v_mul_f32 v101, v101, v93
    v_mul_f32 v102, v102, v94
    v_mul_f32 v103, v103, v95
    v_cvt_pk_bf16_f32 v118, v103, v102
    v_cvt_pk_bf16_f32 v119, v101, v100
    s_add_u32 s53, s55, 24576
    buffer_store_dwordx2 v[118:119], v84, s[28:31], s53 offen
    v_lshlrev_b32 v117, 16, v83
    v_lshlrev_b32 v113, 16, v51
    v_mul_f32 v113, v113, v117
    v_lshlrev_b32 v114, 16, v55
    v_mul_f32 v114, v114, v117
    v_lshlrev_b32 v115, 16, v59
    v_mul_f32 v115, v115, v117
    v_lshlrev_b32 v116, 16, v63
    v_mul_f32 v116, v116, v117
    v_cvt_pk_bf16_f32 v108, v113, v114
    v_lshlrev_b32 v113, 16, v108
    v_and_b32 v114, 0xffff0000, v108
    v_cvt_pk_bf16_f32 v108, v115, v116
    v_lshlrev_b32 v115, 16, v108
    v_and_b32 v116, 0xffff0000, v108
    v_add_f32 v109, v109, v113
    v_add_f32 v110, v110, v114
    v_add_f32 v111, v111, v115
    v_add_f32 v112, v112, v116
    v_and_b32 v85, 0xffff0000, v7
    v_and_b32 v86, 0xffff0000, v11
    v_and_b32 v87, 0xffff0000, v15
    v_and_b32 v88, 0xffff0000, v19
    v_and_b32 v89, 0xffff0000, v23
    v_and_b32 v90, 0xffff0000, v27
    v_and_b32 v91, 0xffff0000, v31
    v_and_b32 v92, 0xffff0000, v35
    v_and_b32 v93, 0xffff0000, v39
    v_and_b32 v94, 0xffff0000, v43
    v_and_b32 v95, 0xffff0000, v47
    v_lshlrev_b32 v96, 16, v78
    v_and_b32 v97, 0xffff0000, v78
    v_lshlrev_b32 v98, 16, v79
    v_and_b32 v99, 0xffff0000, v79
    v_mul_f32 v100, v85, v99
    v_mul_f32 v101, v86, v99
    v_mul_f32 v102, v87, v99
    v_mul_f32 v103, v88, v99
    v_cvt_pk_bf16_f32 v108, v100, v101
    v_lshlrev_b32 v100, 16, v108
    v_and_b32 v101, 0xffff0000, v108
    v_cvt_pk_bf16_f32 v108, v102, v103
    v_lshlrev_b32 v102, 16, v108
    v_and_b32 v103, 0xffff0000, v108
    v_mul_f32 v104, v86, v98
    v_mul_f32 v105, v87, v98
    v_mul_f32 v106, v88, v98
    v_mul_f32 v107, v89, v98
    v_cvt_pk_bf16_f32 v108, v104, v105
    v_lshlrev_b32 v104, 16, v108
    v_and_b32 v105, 0xffff0000, v108
    v_cvt_pk_bf16_f32 v108, v106, v107
    v_lshlrev_b32 v106, 16, v108
    v_and_b32 v107, 0xffff0000, v108
    v_add_f32 v100, v100, v104
    v_add_f32 v101, v101, v105
    v_add_f32 v102, v102, v106
    v_add_f32 v103, v103, v107
    v_cvt_pk_bf16_f32 v108, v100, v101
    v_lshlrev_b32 v100, 16, v108
    v_and_b32 v101, 0xffff0000, v108
    v_cvt_pk_bf16_f32 v108, v102, v103
    v_lshlrev_b32 v102, 16, v108
    v_and_b32 v103, 0xffff0000, v108
    v_mul_f32 v104, v87, v97
    v_mul_f32 v105, v88, v97
    v_mul_f32 v106, v89, v97
    v_mul_f32 v107, v90, v97
    v_cvt_pk_bf16_f32 v108, v104, v105
    v_lshlrev_b32 v104, 16, v108
    v_and_b32 v105, 0xffff0000, v108
    v_cvt_pk_bf16_f32 v108, v106, v107
    v_lshlrev_b32 v106, 16, v108
    v_and_b32 v107, 0xffff0000, v108
    v_add_f32 v100, v100, v104
    v_add_f32 v101, v101, v105
    v_add_f32 v102, v102, v106
    v_add_f32 v103, v103, v107
    v_cvt_pk_bf16_f32 v108, v100, v101
    v_lshlrev_b32 v100, 16, v108
    v_and_b32 v101, 0xffff0000, v108
    v_cvt_pk_bf16_f32 v108, v102, v103
    v_lshlrev_b32 v102, 16, v108
    v_and_b32 v103, 0xffff0000, v108
    v_mul_f32 v104, v88, v96
    v_mul_f32 v105, v89, v96
    v_mul_f32 v106, v90, v96
    v_mul_f32 v107, v91, v96
    v_cvt_pk_bf16_f32 v108, v104, v105
    v_lshlrev_b32 v104, 16, v108
    v_and_b32 v105, 0xffff0000, v108
    v_cvt_pk_bf16_f32 v108, v106, v107
    v_lshlrev_b32 v106, 16, v108
    v_and_b32 v107, 0xffff0000, v108
    v_add_f32 v100, v100, v104
    v_add_f32 v101, v101, v105
    v_add_f32 v102, v102, v106
    v_add_f32 v103, v103, v107
    v_cvt_pk_bf16_f32 v108, v100, v101
    v_lshlrev_b32 v100, 16, v108
    v_and_b32 v101, 0xffff0000, v108
    v_cvt_pk_bf16_f32 v108, v102, v103
    v_lshlrev_b32 v102, 16, v108
    v_and_b32 v103, 0xffff0000, v108
    v_mul_f32 v100, v100, v92
    v_mul_f32 v101, v101, v93
    v_mul_f32 v102, v102, v94
    v_mul_f32 v103, v103, v95
    v_cvt_pk_bf16_f32 v118, v103, v102
    v_cvt_pk_bf16_f32 v119, v101, v100
    s_add_u32 s53, s55, 28672
    buffer_store_dwordx2 v[118:119], v84, s[28:31], s53 offen
    v_and_b32 v117, 0xffff0000, v83
    v_and_b32 v113, 0xffff0000, v51
    v_mul_f32 v113, v113, v117
    v_and_b32 v114, 0xffff0000, v55
    v_mul_f32 v114, v114, v117
    v_and_b32 v115, 0xffff0000, v59
    v_mul_f32 v115, v115, v117
    v_and_b32 v116, 0xffff0000, v63
    v_mul_f32 v116, v116, v117
    v_cvt_pk_bf16_f32 v108, v113, v114
    v_lshlrev_b32 v113, 16, v108
    v_and_b32 v114, 0xffff0000, v108
    v_cvt_pk_bf16_f32 v108, v115, v116
    v_lshlrev_b32 v115, 16, v108
    v_and_b32 v116, 0xffff0000, v108
    v_add_f32 v109, v109, v113
    v_add_f32 v110, v110, v114
    v_add_f32 v111, v111, v115
    v_add_f32 v112, v112, v116
    ds_swizzle_b32 v104, v109 offset:1055
    ds_swizzle_b32 v105, v110 offset:1055
    ds_swizzle_b32 v106, v111 offset:1055
    ds_swizzle_b32 v107, v112 offset:1055
    s_waitcnt lgkmcnt(0)
    v_add_f32 v109, v109, v104
    v_add_f32 v110, v110, v105
    v_add_f32 v111, v111, v106
    v_add_f32 v112, v112, v107
    ds_swizzle_b32 v104, v109 offset:2079
    ds_swizzle_b32 v105, v110 offset:2079
    ds_swizzle_b32 v106, v111 offset:2079
    ds_swizzle_b32 v107, v112 offset:2079
    s_waitcnt lgkmcnt(0)
    v_add_f32 v109, v109, v104
    v_add_f32 v110, v110, v105
    v_add_f32 v111, v111, v106
    v_add_f32 v112, v112, v107
    ds_swizzle_b32 v104, v109 offset:4127
    ds_swizzle_b32 v105, v110 offset:4127
    ds_swizzle_b32 v106, v111 offset:4127
    ds_swizzle_b32 v107, v112 offset:4127
    s_waitcnt lgkmcnt(0)
    v_add_f32 v109, v109, v104
    v_add_f32 v110, v110, v105
    v_add_f32 v111, v111, v106
    v_add_f32 v112, v112, v107
    ds_swizzle_b32 v104, v109 offset:8223
    ds_swizzle_b32 v105, v110 offset:8223
    ds_swizzle_b32 v106, v111 offset:8223
    ds_swizzle_b32 v107, v112 offset:8223
    s_waitcnt lgkmcnt(0)
    v_add_f32 v109, v109, v104
    v_add_f32 v110, v110, v105
    v_add_f32 v111, v111, v106
    v_add_f32 v112, v112, v107
    ds_swizzle_b32 v104, v109 offset:16415
    ds_swizzle_b32 v105, v110 offset:16415
    ds_swizzle_b32 v106, v111 offset:16415
    ds_swizzle_b32 v107, v112 offset:16415
    s_waitcnt lgkmcnt(0)
    v_add_f32 v109, v109, v104
    v_add_f32 v110, v110, v105
    v_add_f32 v111, v111, v106
    v_add_f32 v112, v112, v107
    v_readlane_b32 s56, v109, 32
    v_readlane_b32 s57, v110, 32
    v_readlane_b32 s58, v111, 32
    v_readlane_b32 s59, v112, 32
    v_add_f32 v109, s56, v109
    v_add_f32 v110, s57, v110
    v_add_f32 v111, s58, v111
    v_add_f32 v112, s59, v112
    v_cvt_pk_bf16_f32 v108, v109, v110
    v_lshlrev_b32 v109, 16, v108
    v_and_b32 v110, 0xffff0000, v108
    v_cvt_pk_bf16_f32 v108, v111, v112
    v_lshlrev_b32 v111, 16, v108
    v_and_b32 v112, 0xffff0000, v108
    v_mul_f32 v109, 0xbfb8aa3b, v109
    v_exp_f32 v109, v109
    v_mul_f32 v110, 0xbfb8aa3b, v110
    v_exp_f32 v110, v110
    v_mul_f32 v111, 0xbfb8aa3b, v111
    v_exp_f32 v111, v111
    v_mul_f32 v112, 0xbfb8aa3b, v112
    v_exp_f32 v112, v112
    v_add_f32 v109, 1.0, v109
    v_rcp_f32 v109, v109
    v_add_f32 v110, 1.0, v110
    v_rcp_f32 v110, v110
    v_add_f32 v111, 1.0, v111
    v_rcp_f32 v111, v111
    v_add_f32 v112, 1.0, v112
    v_rcp_f32 v112, v112
    v_cvt_pk_bf16_f32 v108, v109, v110
    v_lshlrev_b32 v109, 16, v108
    v_and_b32 v110, 0xffff0000, v108
    v_cvt_pk_bf16_f32 v108, v111, v112
    v_lshlrev_b32 v111, 16, v108
    v_and_b32 v112, 0xffff0000, v108
    v_mov_b32 v120, v109
    v_mov_b32 v121, v110
    v_mov_b32 v122, v111
    v_mov_b32 v123, v112
    v_mov_b32 v124, 0
    s_lshl_b32 s53, s52, 2
    s_add_u32 s53, s53, 12582912
    s_mov_b64 exec, 1
    buffer_store_dwordx4 v[120:123], v124, s[28:31], s53 offen
k1_qkv_prep_kernel_end2:
    s_endpgm
.section .rodata,"a"
.p2align 6
.amdhsa_kernel k1_qkv_prep_kernel
  .amdhsa_next_free_vgpr 125
  .amdhsa_next_free_sgpr 60
  .amdhsa_accum_offset 128
  .amdhsa_group_segment_fixed_size 0
  .amdhsa_kernarg_size 104
  .amdhsa_user_sgpr_count 2
  .amdhsa_user_sgpr_kernarg_segment_ptr 1
  .amdhsa_system_sgpr_workgroup_id_x 1
  .amdhsa_float_denorm_mode_32 3
  .amdhsa_float_denorm_mode_16_64 3
.end_amdhsa_kernel
.text
.globl k2_attn_conv_kernel
.p2align 8
.type k2_attn_conv_kernel,@function
k2_attn_conv_kernel:
    s_cmp_ge_u32 s2, 256
    s_cbranch_scc1 k2_attn_conv_kernel_end2
    s_load_dwordx2 s[4:5], s[0:1], 96
    s_load_dwordx2 s[6:7], s[0:1], 32
    s_load_dwordx2 s[8:9], s[0:1], 40
    v_lshrrev_b32 v1, 6, v0
    s_nop 0
    v_readfirstlane_b32 s3, v1
    v_and_b32 v1, 63, v0
    v_and_b32 v2, 31, v1
    v_lshrrev_b32 v3, 5, v1
    v_lshlrev_b32 v4, 4, v1
    s_waitcnt lgkmcnt(0)
    s_mov_b32 s12, s4
    s_and_b32 s13, s5, 0xffff
    s_mov_b32 s14, 12648448
    s_mov_b32 s15, 0x00020000
    s_cmp_ge_u32 s3, 8
    s_cbranch_scc1 k2_attn_conv_kernel_conv1
    s_and_b32 s10, s2, 31
    s_lshr_b32 s11, s2, 5
    v_lshlrev_b32 v5, 5, v2
    v_lshl_add_u32 v5, v3, 4, v5
    s_lshl_b32 s16, s10, 16
    s_lshl_b32 s17, s11, 13
    s_add_u32 s16, s16, s17
    s_lshl_b32 s17, s3, 10
    s_add_u32 s16, s16, s17
    s_add_u32 s16, s16, 0
    buffer_load_dwordx4 v[8:11], v5, s[12:15], s16 offen
    s_lshl_b32 s18, s10, 16
    s_add_u32 s18, s18, 2097152
    s_lshl_b32 s16, s3, 11
    s_add_u32 s18, s18, s16
    s_lshl_b32 s19, s10, 16
    s_add_u32 s19, s19, 4194304
    s_lshl_b32 s16, s3, 13
    s_add_u32 s19, s19, s16
    s_lshl_b32 s20, s3, 11
    s_mul_i32 s21, s3, 8224
    s_add_u32 s16, s18, 0
    s_add_u32 m0, s20, 0
    s_nop 0
    buffer_load_dwordx4 v4, s[12:15], s16 offen lds
    s_add_u32 s16, s18, 1024
    s_add_u32 m0, s20, 1024
    s_nop 0
    buffer_load_dwordx4 v4, s[12:15], s16 offen lds
    s_add_u32 s16, s19, 0
    s_add_u32 m0, s21, 65536
    s_nop 0
    buffer_load_dwordx4 v4, s[12:15], s16 offen lds
    s_add_u32 s16, s19, 4096
    s_add_u32 m0, s21, 69648
    s_nop 0
    buffer_load_dwordx4 v4, s[12:15], s16 offen lds
    s_add_u32 s16, s18, 16384
    s_add_u32 m0, s20, 16384
    s_nop 0
    buffer_load_dwordx4 v4, s[12:15], s16 offen lds
    s_add_u32 s16, s18, 17408
    s_add_u32 m0, s20, 17408
    s_nop 0
    buffer_load_dwordx4 v4, s[12:15], s16 offen lds
    s_add_u32 s16, s19, 1024
    s_add_u32 m0, s21, 66560
    s_nop 0
    buffer_load_dwordx4 v4, s[12:15], s16 offen lds
    s_add_u32 s16, s19, 5120
    s_add_u32 m0, s21, 70672
    s_nop 0
    buffer_load_dwordx4 v4, s[12:15], s16 offen lds
    s_add_u32 s16, s18, 32768
    s_add_u32 m0, s20, 32768
    s_nop 0
    buffer_load_dwordx4 v4, s[12:15], s16 offen lds
    s_add_u32 s16, s18, 33792
    s_add_u32 m0, s20, 33792
    s_nop 0
    buffer_load_dwordx4 v4, s[12:15], s16 offen lds
    s_add_u32 s16, s19, 2048
    s_add_u32 m0, s21, 67584
    s_nop 0
    buffer_load_dwordx4 v4, s[12:15], s16 offen lds
    s_add_u32 s16, s19, 6144
    s_add_u32 m0, s21, 71696
    s_nop 0
    buffer_load_dwordx4 v4, s[12:15], s16 offen lds
    s_add_u32 s16, s18, 49152
    s_add_u32 m0, s20, 49152
    s_nop 0
    buffer_load_dwordx4 v4, s[12:15], s16 offen lds
    s_add_u32 s16, s18, 50176
    s_add_u32 m0, s20, 50176
    s_nop 0
    buffer_load_dwordx4 v4, s[12:15], s16 offen lds
    s_add_u32 s16, s19, 3072
    s_add_u32 m0, s21, 68608
    s_nop 0
    buffer_load_dwordx4 v4, s[12:15], s16 offen lds
    s_add_u32 s16, s19, 7168
    s_add_u32 m0, s21, 72720
    s_nop 0
    buffer_load_dwordx4 v4, s[12:15], s16 offen lds
    v_mov_b32 v28, 0
    v_mov_b32 v29, 0
    v_mov_b32 v30, 0
    v_mov_b32 v31, 0
    v_mov_b32 v32, 0
    v_mov_b32 v33, 0
    v_mov_b32 v34, 0
    v_mov_b32 v35, 0
    v_mov_b32 v36, 0
    v_mov_b32 v37, 0
    v_mov_b32 v38, 0
    v_mov_b32 v39, 0
    v_mov_b32 v40, 0
    v_mov_b32 v41, 0
    v_mov_b32 v42, 0
    v_mov_b32 v43, 0
    v_cmp_eq_u32 vcc, 16, v2
    v_mov_b32 v110, 0x3f803f80
    s_nop 0
    v_cndmask_b32 v111, 0, v110, vcc
    v_mov_b32 v84, v111
    v_mov_b32 v85, v111
    v_mov_b32 v86, v111
    v_mov_b32 v87, v111
    v_mov_b32 v88, v111
    v_mov_b32 v89, v111
    v_mov_b32 v90, v111
    v_mov_b32 v91, v111
    v_mov_b32 v92, v111
    v_mov_b32 v93, v111
    v_mov_b32 v94, v111
    v_mov_b32 v95, v111
    v_mov_b32 v96, v111
    v_mov_b32 v97, v111
    v_mov_b32 v98, v111
    v_mov_b32 v99, v111
    v_lshlrev_b32 v6, 5, v2
    v_lshl_add_u32 v6, v3, 4, v6
    s_mov_b32 s22, 4112
    v_mul_lo_u32 v7, v2, s22
    v_lshl_add_u32 v7, v3, 4, v7
    v_add_u32 v7, 65536, v7
    v_cmp_lt_u32 vcc, 15, v2
    v_lshlrev_b32 v110, 4, v3
    v_add_u32 v110, 160768, v110
    v_cndmask_b32 v7, v7, v110, vcc
    v_mov_b32 v110, 128
    v_cndmask_b32 v109, v110, 0, vcc
    v_cmp_eq_u32 vcc, 16, v2
    v_lshlrev_b32 v110, 4, v3
    v_add_u32 v110, 160512, v110
    v_cndmask_b32 v7, v7, v110, vcc
    v_cmp_gt_u32 vcc, 32, v1
    v_mov_b32 v110, 0x3f803f80
    s_nop 0
    v_cndmask_b32 v110, 0, v110, vcc
    v_mov_b32 v111, v110
    v_lshlrev_b32 v5, 3, v1
    v_add_u32 v5, 160512, v5
    ds_write_b64 v5, v[110:111]
    s_mov_b32 s24, 0x0000ffff
    s_mov_b32 s25, 0x0000ffff
    s_waitcnt vmcnt(16)
    v_lshlrev_b32 v112, 16, v8
    v_and_b32 v113, 0xffff0000, v8
    v_mul_f32 v112, 0x3eb8aa3b, v112
    v_mul_f32 v113, 0x3eb8aa3b, v113
    v_cvt_pk_bf16_f32 v8, v112, v113
    v_lshlrev_b32 v112, 16, v9
    v_and_b32 v113, 0xffff0000, v9
    v_mul_f32 v112, 0x3eb8aa3b, v112
    v_mul_f32 v113, 0x3eb8aa3b, v113
    v_cvt_pk_bf16_f32 v9, v112, v113
    v_lshlrev_b32 v112, 16, v10
    v_and_b32 v113, 0xffff0000, v10
    v_mul_f32 v112, 0x3eb8aa3b, v112
    v_mul_f32 v113, 0x3eb8aa3b, v113
    v_cvt_pk_bf16_f32 v10, v112, v113
    v_lshlrev_b32 v112, 16, v11
    v_and_b32 v113, 0xffff0000, v11
    v_mul_f32 v112, 0x3eb8aa3b, v112
    v_mul_f32 v113, 0x3eb8aa3b, v113
    v_cvt_pk_bf16_f32 v11, v112, v113
    v_mov_b32 v112, 0
    v_dot2_f32_bf16 v112, v8, v8, v112
    v_dot2_f32_bf16 v112, v9, v9, v112
    v_dot2_f32_bf16 v112, v10, v10, v112
    v_dot2_f32_bf16 v112, v11, v11, v112
    s_waitcnt vmcnt(12) lgkmcnt(0)
    s_barrier
    ds_read_b128 v[76:79], v6
    v_mov_b32 v12, 0
    v_mov_b32 v13, 0
    v_mov_b32 v14, 0
    v_mov_b32 v15, 0
    v_mov_b32 v16, 0
    v_mov_b32 v17, 0
    v_mov_b32 v18, 0
    v_mov_b32 v19, 0
    v_mov_b32 v20, 0
    v_mov_b32 v21, 0
    v_mov_b32 v22, 0
    v_mov_b32 v23, 0
    v_mov_b32 v24, 0
    v_mov_b32 v25, 0
    v_mov_b32 v26, 0
    v_mov_b32 v27, 0
    s_waitcnt lgkmcnt(0)
    s_nop 0
    v_mfma_f32_32x32x16_bf16 v[44:59], v[76:79], v[8:11], v[12:27]
    s_nop 11
    v_max3_f32 v108, v44, v45, v46
    v_max3_f32 v108, v108, v47, v48
    v_max3_f32 v108, v108, v49, v50
    v_max3_f32 v108, v108, v51, v52
    v_max3_f32 v108, v108, v53, v54
    v_max3_f32 v108, v108, v55, v56
    v_max3_f32 v108, v108, v57, v58
    v_max_f32 v108, v108, v59
    v_mov_b32 v110, v108
    v_mov_b32 v111, v108
    s_nop 1
    v_permlane32_swap_b32 v110, v111
    v_max_f32 v108, v110, v111
    v_sub_f32 v12, 0, v108
    v_sub_f32 v13, 0, v108
    v_sub_f32 v14, 0, v108
    v_sub_f32 v15, 0, v108
    v_sub_f32 v16, 0, v108
    v_sub_f32 v17, 0, v108
    v_sub_f32 v18, 0, v108
    v_sub_f32 v19, 0, v108
    v_sub_f32 v20, 0, v108
    v_sub_f32 v21, 0, v108
    v_sub_f32 v22, 0, v108
    v_sub_f32 v23, 0, v108
    v_sub_f32 v24, 0, v108
    v_sub_f32 v25, 0, v108
    v_sub_f32 v26, 0, v108
    v_sub_f32 v27, 0, v108
    s_nop 1
    v_mfma_f32_32x32x16_bf16 v[44:59], v[76:79], v[8:11], v[12:27]
    ds_read_b128 v[80:83], v6 offset:1024
    ds_read_b128 v[84:87], v7
    ds_read_b128 v[88:91], v7 offset:32
    s_nop 8
    v_max3_f32 v108, v44, v45, v46
    v_max3_f32 v108, v108, v47, v48
    v_max3_f32 v108, v108, v49, v50
    v_max3_f32 v108, v108, v51, v52
    v_max3_f32 v108, v108, v53, v54
    v_max3_f32 v108, v108, v55, v56
    v_max3_f32 v108, v108, v57, v58
    v_max_f32 v108, v108, v59
    v_cmp_lt_f32 vcc, 0x41200000, v108
    s_mov_b32 s23, 0
k2_attn_conv_kernel_loop3:
    s_cbranch_vccnz k2_attn_conv_kernel_rare4
k2_attn_conv_kernel_cont5:
    v_exp_f32 v44, v44
    v_exp_f32 v45, v45
    v_exp_f32 v46, v46
    v_exp_f32 v47, v47
    s_waitcnt lgkmcnt(2)
    v_mfma_f32_32x32x16_bf16 v[60:75], v[80:83], v[8:11], v[12:27]
    v_exp_f32 v48, v48
    v_exp_f32 v49, v49
    v_exp_f32 v50, v50
    v_exp_f32 v51, v51
    v_cvt_pk_bf16_f32 v100, v44, v45
    v_cvt_pk_bf16_f32 v101, v46, v47
    v_cvt_pk_bf16_f32 v102, v48, v49
    v_cvt_pk_bf16_f32 v103, v50, v51
    v_exp_f32 v52, v52
    v_exp_f32 v53, v53
    s_waitcnt lgkmcnt(0)
    v_mfma_f32_32x32x16_bf16 v[28:43], v[84:87], v[100:103], v[28:43]
    ds_read_b128 v[76:79], v6 offset:2048
    ds_read_b128 v[92:95], v7 offset:64
    ds_read_b128 v[96:99], v7 offset:96
    v_exp_f32 v54, v54
    v_exp_f32 v55, v55
    v_exp_f32 v56, v56
    v_exp_f32 v57, v57
    v_exp_f32 v58, v58
    v_exp_f32 v59, v59
    v_cvt_pk_bf16_f32 v104, v52, v53
    v_cvt_pk_bf16_f32 v105, v54, v55
    v_cvt_pk_bf16_f32 v106, v56, v57
    v_cvt_pk_bf16_f32 v107, v58, v59
    v_max3_f32 v108, v60, v61, v62
    v_max3_f32 v108, v108, v63, v64
    v_max3_f32 v108, v108, v65, v66
    v_max3_f32 v108, v108, v67, v68
    v_max3_f32 v108, v108, v69, v70
    v_max3_f32 v108, v108, v71, v72
    v_max3_f32 v108, v108, v73, v74
    v_max_f32 v108, v108, v75
    v_cmp_lt_f32 vcc, 0x41200000, v108
    v_mfma_f32_32x32x16_bf16 v[28:43], v[88:91], v[104:107], v[28:43]
    s_cbranch_vccnz k2_attn_conv_kernel_rare6
k2_attn_conv_kernel_cont7:
    v_exp_f32 v60, v60
    v_exp_f32 v61, v61
    v_exp_f32 v62, v62
    v_exp_f32 v63, v63
    s_waitcnt lgkmcnt(2)
    v_mfma_f32_32x32x16_bf16 v[44:59], v[76:79], v[8:11], v[12:27]
    v_exp_f32 v64, v64
    v_exp_f32 v65, v65
    v_exp_f32 v66, v66
    v_exp_f32 v67, v67
    v_cvt_pk_bf16_f32 v100, v60, v61
    v_cvt_pk_bf16_f32 v101, v62, v63
    v_cvt_pk_bf16_f32 v102, v64, v65
    v_cvt_pk_bf16_f32 v103, v66, v67
    v_exp_f32 v68, v68
    v_exp_f32 v69, v69
    s_waitcnt lgkmcnt(0)
    v_mfma_f32_32x32x16_bf16 v[28:43], v[92:95], v[100:103], v[28:43]
    ds_read_b128 v[80:83], v6 offset:3072
    ds_read_b128 v[84:87], v7 offset:128
    ds_read_b128 v[88:91], v7 offset:160
    v_exp_f32 v70, v70
    v_exp_f32 v71, v71
    v_exp_f32 v72, v72
    v_exp_f32 v73, v73
    v_exp_f32 v74, v74
    v_exp_f32 v75, v75
    v_cvt_pk_bf16_f32 v104, v68, v69
    v_cvt_pk_bf16_f32 v105, v70, v71
    v_cvt_pk_bf16_f32 v106, v72, v73
    v_cvt_pk_bf16_f32 v107, v74, v75
    v_max3_f32 v108, v44, v45, v46
    v_max3_f32 v108, v108, v47, v48
    v_max3_f32 v108, v108, v49, v50
    v_max3_f32 v108, v108, v51, v52
    v_max3_f32 v108, v108, v53, v54
    v_max3_f32 v108, v108, v55, v56
    v_max3_f32 v108, v108, v57, v58
    v_max_f32 v108, v108, v59
    v_cmp_lt_f32 vcc, 0x41200000, v108
    v_mfma_f32_32x32x16_bf16 v[28:43], v[96:99], v[104:107], v[28:43]
    v_add_u32 v6, 2048, v6
    v_add_u32 v7, v109, v7
    s_add_u32 s23, s23, 1
    s_cmp_lt_u32 s23, 7
    s_cbranch_scc1 k2_attn_conv_kernel_loop3
    s_waitcnt vmcnt(0)
    s_barrier
    v_lshlrev_b32 v114, 5, v1
    s_lshl_b32 s16, s3, 13
    v_add_u32 v114, s16, v114
    v_mov_b32 v113, 0
    ds_read_b128 v[100:103], v114 offset:0
    ds_read_b128 v[104:107], v114 offset:16
    v_mov_b32 v110, 0
    s_waitcnt lgkmcnt(0)
    v_dot2_f32_bf16 v110, v100, v100, v110
    v_dot2_f32_bf16 v110, v101, v101, v110
    v_dot2_f32_bf16 v110, v102, v102, v110
    v_dot2_f32_bf16 v110, v103, v103, v110
    v_dot2_f32_bf16 v110, v104, v104, v110
    v_dot2_f32_bf16 v110, v105, v105, v110
    v_dot2_f32_bf16 v110, v106, v106, v110
    v_dot2_f32_bf16 v110, v107, v107, v110
    v_max_f32 v113, v113, v110
    ds_read_b128 v[100:103], v114 offset:2048
    ds_read_b128 v[104:107], v114 offset:2064
    v_mov_b32 v110, 0
    s_waitcnt lgkmcnt(0)
    v_dot2_f32_bf16 v110, v100, v100, v110
    v_dot2_f32_bf16 v110, v101, v101, v110
    v_dot2_f32_bf16 v110, v102, v102, v110
    v_dot2_f32_bf16 v110, v103, v103, v110
    v_dot2_f32_bf16 v110, v104, v104, v110
    v_dot2_f32_bf16 v110, v105, v105, v110
    v_dot2_f32_bf16 v110, v106, v106, v110
    v_dot2_f32_bf16 v110, v107, v107, v110
    v_max_f32 v113, v113, v110
    ds_read_b128 v[100:103], v114 offset:4096
    ds_read_b128 v[104:107], v114 offset:4112
    v_mov_b32 v110, 0
    s_waitcnt lgkmcnt(0)
    v_dot2_f32_bf16 v110, v100, v100, v110
    v_dot2_f32_bf16 v110, v101, v101, v110
    v_dot2_f32_bf16 v110, v102, v102, v110
    v_dot2_f32_bf16 v110, v103, v103, v110
    v_dot2_f32_bf16 v110, v104, v104, v110
    v_dot2_f32_bf16 v110, v105, v105, v110
    v_dot2_f32_bf16 v110, v106, v106, v110
    v_dot2_f32_bf16 v110, v107, v107, v110
    v_max_f32 v113, v113, v110
    ds_read_b128 v[100:103], v114 offset:6144
    ds_read_b128 v[104:107], v114 offset:6160
    v_mov_b32 v110, 0
    s_waitcnt lgkmcnt(0)
    v_dot2_f32_bf16 v110, v100, v100, v110
    v_dot2_f32_bf16 v110, v101, v101, v110
    v_dot2_f32_bf16 v110, v102, v102, v110
    v_dot2_f32_bf16 v110, v103, v103, v110
    v_dot2_f32_bf16 v110, v104, v104, v110
    v_dot2_f32_bf16 v110, v105, v105, v110
    v_dot2_f32_bf16 v110, v106, v106, v110
    v_dot2_f32_bf16 v110, v107, v107, v110
    v_max_f32 v113, v113, v110
    ds_swizzle_b32 v110, v113 offset:1055
    s_waitcnt lgkmcnt(0)
    v_max_f32 v113, v113, v110
    ds_swizzle_b32 v110, v113 offset:2079
    s_waitcnt lgkmcnt(0)
    v_max_f32 v113, v113, v110
    ds_swizzle_b32 v110, v113 offset:4127
    s_waitcnt lgkmcnt(0)
    v_max_f32 v113, v113, v110
    ds_swizzle_b32 v110, v113 offset:8223
    s_waitcnt lgkmcnt(0)
    v_max_f32 v113, v113, v110
    ds_swizzle_b32 v110, v113 offset:16415
    s_waitcnt lgkmcnt(0)
    v_max_f32 v113, v113, v110
    v_mov_b32 v110, v113
    v_mov_b32 v111, v113
    s_nop 1
    v_permlane32_swap_b32 v110, v111
    v_max_f32 v113, v110, v111
    s_mul_i32 s16, s3, 4112
    s_add_u32 s16, s16, 69632
    v_mov_b32 v114, s16
    ds_write_b32 v114, v113
    s_waitcnt lgkmcnt(0)
    s_barrier
    v_mov_b32 v114, 69632
    ds_read_b32 v100, v114 offset:0
    ds_read_b32 v101, v114 offset:4112
    ds_read_b32 v102, v114 offset:8224
    ds_read_b32 v103, v114 offset:12336
    ds_read_b32 v104, v114 offset:16448
    ds_read_b32 v105, v114 offset:20560
    ds_read_b32 v106, v114 offset:24672
    ds_read_b32 v107, v114 offset:28784
    s_waitcnt lgkmcnt(0)
    v_max_f32 v113, v113, v100
    v_max_f32 v113, v113, v101
    v_max_f32 v113, v113, v102
    v_max_f32 v113, v113, v103
    v_max_f32 v113, v113, v104
    v_max_f32 v113, v113, v105
    v_max_f32 v113, v113, v106
    v_max_f32 v113, v113, v107
    v_mov_b32 v110, v112
    v_mov_b32 v111, v112
    s_nop 1
    v_permlane32_swap_b32 v110, v111
    v_add_f32 v110, v110, v111
    v_mul_f32 v110, v110, v113
    v_sqrt_f32 v110, v110
    s_nop 0
    v_add_f32 v110, v110, v12
    v_cmp_lt_f32 vcc, 0x42700000, v110
    s_cbranch_vccnz k2_attn_conv_kernel_chk8
    s_mov_b32 s23, 0
k2_attn_conv_kernel_loop10:
    v_exp_f32 v44, v44
    v_exp_f32 v45, v45
    v_exp_f32 v46, v46
    v_exp_f32 v47, v47
    s_waitcnt lgkmcnt(2)
    v_mfma_f32_32x32x16_bf16 v[60:75], v[80:83], v[8:11], v[12:27]
    v_exp_f32 v48, v48
    v_exp_f32 v49, v49
    v_exp_f32 v50, v50
    v_exp_f32 v51, v51
    v_cvt_pk_bf16_f32 v100, v44, v45
    v_cvt_pk_bf16_f32 v101, v46, v47
    v_cvt_pk_bf16_f32 v102, v48, v49
    v_cvt_pk_bf16_f32 v103, v50, v51
    v_exp_f32 v52, v52
    v_exp_f32 v53, v53
    s_waitcnt lgkmcnt(0)
    v_mfma_f32_32x32x16_bf16 v[28:43], v[84:87], v[100:103], v[28:43]
    ds_read_b128 v[76:79], v6 offset:2048
    ds_read_b128 v[92:95], v7 offset:64
    ds_read_b128 v[96:99], v7 offset:96
    v_exp_f32 v54, v54
    v_exp_f32 v55, v55
    v_exp_f32 v56, v56
    v_exp_f32 v57, v57
    v_exp_f32 v58, v58
    v_exp_f32 v59, v59
    v_cvt_pk_bf16_f32 v104, v52, v53
    v_cvt_pk_bf16_f32 v105, v54, v55
    v_cvt_pk_bf16_f32 v106, v56, v57
    v_cvt_pk_bf16_f32 v107, v58, v59
    s_nop 1
    v_mfma_f32_32x32x16_bf16 v[28:43], v[88:91], v[104:107], v[28:43]
    v_exp_f32 v60, v60
    v_exp_f32 v61, v61
    v_exp_f32 v62, v62
    v_exp_f32 v63, v63
    s_waitcnt lgkmcnt(2)
    v_mfma_f32_32x32x16_bf16 v[44:59], v[76:79], v[8:11], v[12:27]
    v_exp_f32 v64, v64
    v_exp_f32 v65, v65
    v_exp_f32 v66, v66
    v_exp_f32 v67, v67
    v_cvt_pk_bf16_f32 v100, v60, v61
    v_cvt_pk_bf16_f32 v101, v62, v63
    v_cvt_pk_bf16_f32 v102, v64, v65
    v_cvt_pk_bf16_f32 v103, v66, v67
    v_exp_f32 v68, v68
    v_exp_f32 v69, v69
    s_waitcnt lgkmcnt(0)
    v_mfma_f32_32x32x16_bf16 v[28:43], v[92:95], v[100:103], v[28:43]
    ds_read_b128 v[80:83], v6 offset:3072
    ds_read_b128 v[84:87], v7 offset:128
    ds_read_b128 v[88:91], v7 offset:160
    v_exp_f32 v70, v70
    v_exp_f32 v71, v71
    v_exp_f32 v72, v72
    v_exp_f32 v73, v73
    v_exp_f32 v74, v74
    v_exp_f32 v75, v75
    v_cvt_pk_bf16_f32 v104, v68, v69
    v_cvt_pk_bf16_f32 v105, v70, v71
    v_cvt_pk_bf16_f32 v106, v72, v73
    v_cvt_pk_bf16_f32 v107, v74, v75
    s_nop 1
    v_mfma_f32_32x32x16_bf16 v[28:43], v[96:99], v[104:107], v[28:43]
    v_add_u32 v6, 2048, v6
    v_add_u32 v7, v109, v7
    s_add_u32 s23, s23, 1
    s_cmp_lt_u32 s23, 25
    s_cbranch_scc1 k2_attn_conv_kernel_loop10
    s_branch k2_attn_conv_kernel_adone9
k2_attn_conv_kernel_chk8:
    v_max3_f32 v108, v44, v45, v46
    v_max3_f32 v108, v108, v47, v48
    v_max3_f32 v108, v108, v49, v50
    v_max3_f32 v108, v108, v51, v52
    v_max3_f32 v108, v108, v53, v54
    v_max3_f32 v108, v108, v55, v56
    v_max3_f32 v108, v108, v57, v58
    v_max_f32 v108, v108, v59
    v_cmp_lt_f32 vcc, 0x41200000, v108
    s_mov_b32 s23, 0
k2_attn_conv_kernel_loop15:
    s_cbranch_vccnz k2_attn_conv_kernel_rare16
k2_attn_conv_kernel_cont17:
    v_exp_f32 v44, v44
    v_exp_f32 v45, v45
    v_exp_f32 v46, v46
    v_exp_f32 v47, v47
    s_waitcnt lgkmcnt(2)
    v_mfma_f32_32x32x16_bf16 v[60:75], v[80:83], v[8:11], v[12:27]
    v_exp_f32 v48, v48
    v_exp_f32 v49, v49
    v_exp_f32 v50, v50
    v_exp_f32 v51, v51
    v_cvt_pk_bf16_f32 v100, v44, v45
    v_cvt_pk_bf16_f32 v101, v46, v47
    v_cvt_pk_bf16_f32 v102, v48, v49
    v_cvt_pk_bf16_f32 v103, v50, v51
    v_exp_f32 v52, v52
    v_exp_f32 v53, v53
    s_waitcnt lgkmcnt(0)
    v_mfma_f32_32x32x16_bf16 v[28:43], v[84:87], v[100:103], v[28:43]
    ds_read_b128 v[76:79], v6 offset:2048
    ds_read_b128 v[92:95], v7 offset:64
    ds_read_b128 v[96:99], v7 offset:96
    v_exp_f32 v54, v54
    v_exp_f32 v55, v55
    v_exp_f32 v56, v56
    v_exp_f32 v57, v57
    v_exp_f32 v58, v58
    v_exp_f32 v59, v59
    v_cvt_pk_bf16_f32 v104, v52, v53
    v_cvt_pk_bf16_f32 v105, v54, v55
    v_cvt_pk_bf16_f32 v106, v56, v57
    v_cvt_pk_bf16_f32 v107, v58, v59
    v_max3_f32 v108, v60, v61, v62
    v_max3_f32 v108, v108, v63, v64
    v_max3_f32 v108, v108, v65, v66
    v_max3_f32 v108, v108, v67, v68
    v_max3_f32 v108, v108, v69, v70
    v_max3_f32 v108, v108, v71, v72
    v_max3_f32 v108, v108, v73, v74
    v_max_f32 v108, v108, v75
    v_cmp_lt_f32 vcc, 0x41200000, v108
    v_mfma_f32_32x32x16_bf16 v[28:43], v[88:91], v[104:107], v[28:43]
    s_cbranch_vccnz k2_attn_conv_kernel_rare18
k2_attn_conv_kernel_cont19:
    v_exp_f32 v60, v60
    v_exp_f32 v61, v61
    v_exp_f32 v62, v62
    v_exp_f32 v63, v63
    s_waitcnt lgkmcnt(2)
    v_mfma_f32_32x32x16_bf16 v[44:59], v[76:79], v[8:11], v[12:27]
    v_exp_f32 v64, v64
    v_exp_f32 v65, v65
    v_exp_f32 v66, v66
    v_exp_f32 v67, v67
    v_cvt_pk_bf16_f32 v100, v60, v61
    v_cvt_pk_bf16_f32 v101, v62, v63
    v_cvt_pk_bf16_f32 v102, v64, v65
    v_cvt_pk_bf16_f32 v103, v66, v67
    v_exp_f32 v68, v68
    v_exp_f32 v69, v69
    s_waitcnt lgkmcnt(0)
    v_mfma_f32_32x32x16_bf16 v[28:43], v[92:95], v[100:103], v[28:43]
    ds_read_b128 v[80:83], v6 offset:3072
    ds_read_b128 v[84:87], v7 offset:128
    ds_read_b128 v[88:91], v7 offset:160
    v_exp_f32 v70, v70
    v_exp_f32 v71, v71
    v_exp_f32 v72, v72
    v_exp_f32 v73, v73
    v_exp_f32 v74, v74
    v_exp_f32 v75, v75
    v_cvt_pk_bf16_f32 v104, v68, v69
    v_cvt_pk_bf16_f32 v105, v70, v71
    v_cvt_pk_bf16_f32 v106, v72, v73
    v_cvt_pk_bf16_f32 v107, v74, v75
    v_max3_f32 v108, v44, v45, v46
    v_max3_f32 v108, v108, v47, v48
    v_max3_f32 v108, v108, v49, v50
    v_max3_f32 v108, v108, v51, v52
    v_max3_f32 v108, v108, v53, v54
    v_max3_f32 v108, v108, v55, v56
    v_max3_f32 v108, v108, v57, v58
    v_max_f32 v108, v108, v59
    v_cmp_lt_f32 vcc, 0x41200000, v108
    v_mfma_f32_32x32x16_bf16 v[28:43], v[96:99], v[104:107], v[28:43]
    v_add_u32 v6, 2048, v6
    v_add_u32 v7, v109, v7
    s_add_u32 s23, s23, 1
    s_cmp_lt_u32 s23, 25
    s_cbranch_scc1 k2_attn_conv_kernel_loop15
k2_attn_conv_kernel_adone9:
    s_nop 6
    s_waitcnt lgkmcnt(0)
    v_mov_b32 v110, v36
    v_mov_b32 v111, v36
    s_nop 1
    v_permlane32_swap_b32 v110, v111
    v_rcp_f32 v110, v110
    s_nop 0
    v_mul_f32 v28, v28, v110
    v_mul_f32 v29, v29, v110
    v_mul_f32 v30, v30, v110
    v_mul_f32 v31, v31, v110
    v_mul_f32 v32, v32, v110
    v_mul_f32 v33, v33, v110
    v_mul_f32 v34, v34, v110
    v_mul_f32 v35, v35, v110
    v_cvt_pk_bf16_f32 v100, v28, v29
    v_cvt_pk_bf16_f32 v101, v30, v31
    v_cvt_pk_bf16_f32 v102, v32, v33
    v_cvt_pk_bf16_f32 v103, v34, v35
    v_lshlrev_b32 v5, 10, v2
    v_lshl_add_u32 v5, v3, 3, v5
    s_lshl_b32 s16, s11, 18
    s_lshl_b32 s17, s3, 15
    s_add_u32 s16, s16, s17
    s_lshl_b32 s17, s10, 5
    s_add_u32 s16, s16, s17
    s_add_u32 s16, s16, 10485760
    buffer_store_dwordx2 v[100:101], v5, s[12:15], s16 offen
    buffer_store_dwordx2 v[102:103], v5, s[12:15], s16 offen offset:16
    s_endpgm
k2_attn_conv_kernel_rare4:
    s_nop 15
    s_nop 15
    v_mov_b32 v110, v108
    v_mov_b32 v111, v108
    s_nop 1
    v_permlane32_swap_b32 v110, v111
    v_max_f32 v108, v110, v111
    v_max_f32 v108, 0, v108
    v_sub_f32 v44, v44, v108
    v_sub_f32 v45, v45, v108
    v_sub_f32 v46, v46, v108
    v_sub_f32 v47, v47, v108
    v_sub_f32 v48, v48, v108
    v_sub_f32 v49, v49, v108
    v_sub_f32 v50, v50, v108
    v_sub_f32 v51, v51, v108
    v_sub_f32 v52, v52, v108
    v_sub_f32 v53, v53, v108
    v_sub_f32 v54, v54, v108
    v_sub_f32 v55, v55, v108
    v_sub_f32 v56, v56, v108
    v_sub_f32 v57, v57, v108
    v_sub_f32 v58, v58, v108
    v_sub_f32 v59, v59, v108
    v_sub_f32 v12, v12, v108
    v_sub_f32 v13, v13, v108
    v_sub_f32 v14, v14, v108
    v_sub_f32 v15, v15, v108
    v_sub_f32 v16, v16, v108
    v_sub_f32 v17, v17, v108
    v_sub_f32 v18, v18, v108
    v_sub_f32 v19, v19, v108
    v_sub_f32 v20, v20, v108
    v_sub_f32 v21, v21, v108
    v_sub_f32 v22, v22, v108
    v_sub_f32 v23, v23, v108
    v_sub_f32 v24, v24, v108
    v_sub_f32 v25, v25, v108
    v_sub_f32 v26, v26, v108
    v_sub_f32 v27, v27, v108
    v_sub_f32 v110, 0, v108
    v_exp_f32 v110, v110
    s_nop 0
    v_mul_f32 v28, v28, v110
    v_mul_f32 v29, v29, v110
    v_mul_f32 v30, v30, v110
    v_mul_f32 v31, v31, v110
    v_mul_f32 v32, v32, v110
    v_mul_f32 v33, v33, v110
    v_mul_f32 v34, v34, v110
    v_mul_f32 v35, v35, v110
    v_mul_f32 v36, v36, v110
    s_nop 1
    s_branch k2_attn_conv_kernel_cont5
k2_attn_conv_kernel_rare6:
    s_nop 15
    s_nop 15
    v_mov_b32 v110, v108
    v_mov_b32 v111, v108
    s_nop 1
    v_permlane32_swap_b32 v110, v111
    v_max_f32 v108, v110, v111
    v_max_f32 v108, 0, v108
    v_sub_f32 v60, v60, v108
    v_sub_f32 v61, v61, v108
    v_sub_f32 v62, v62, v108
    v_sub_f32 v63, v63, v108
    v_sub_f32 v64, v64, v108
    v_sub_f32 v65, v65, v108
    v_sub_f32 v66, v66, v108
    v_sub_f32 v67, v67, v108
    v_sub_f32 v68, v68, v108
    v_sub_f32 v69, v69, v108
    v_sub_f32 v70, v70, v108
    v_sub_f32 v71, v71, v108
    v_sub_f32 v72, v72, v108
    v_sub_f32 v73, v73, v108
    v_sub_f32 v74, v74, v108
    v_sub_f32 v75, v75, v108
    v_sub_f32 v12, v12, v108
    v_sub_f32 v13, v13, v108
    v_sub_f32 v14, v14, v108
    v_sub_f32 v15, v15, v108
    v_sub_f32 v16, v16, v108
    v_sub_f32 v17, v17, v108
    v_sub_f32 v18, v18, v108
    v_sub_f32 v19, v19, v108
    v_sub_f32 v20, v20, v108
    v_sub_f32 v21, v21, v108
    v_sub_f32 v22, v22, v108
    v_sub_f32 v23, v23, v108
    v_sub_f32 v24, v24, v108
    v_sub_f32 v25, v25, v108
    v_sub_f32 v26, v26, v108
    v_sub_f32 v27, v27, v108
    v_sub_f32 v110, 0, v108
    v_exp_f32 v110, v110
    s_nop 0
    v_mul_f32 v28, v28, v110
    v_mul_f32 v29, v29, v110
    v_mul_f32 v30, v30, v110
    v_mul_f32 v31, v31, v110
    v_mul_f32 v32, v32, v110
    v_mul_f32 v33, v33, v110
    v_mul_f32 v34, v34, v110
    v_mul_f32 v35, v35, v110
    v_mul_f32 v36, v36, v110
    s_nop 1
    s_branch k2_attn_conv_kernel_cont7
k2_attn_conv_kernel_rare16:
    s_nop 15
    s_nop 15
    v_mov_b32 v110, v108
    v_mov_b32 v111, v108
    s_nop 1
    v_permlane32_swap_b32 v110, v111
    v_max_f32 v108, v110, v111
    v_max_f32 v108, 0, v108
    v_sub_f32 v44, v44, v108
    v_sub_f32 v45, v45, v108
    v_sub_f32 v46, v46, v108
    v_sub_f32 v47, v47, v108
    v_sub_f32 v48, v48, v108
    v_sub_f32 v49, v49, v108
    v_sub_f32 v50, v50, v108
    v_sub_f32 v51, v51, v108
    v_sub_f32 v52, v52, v108
    v_sub_f32 v53, v53, v108
    v_sub_f32 v54, v54, v108
    v_sub_f32 v55, v55, v108
    v_sub_f32 v56, v56, v108
    v_sub_f32 v57, v57, v108
    v_sub_f32 v58, v58, v108
    v_sub_f32 v59, v59, v108
    v_sub_f32 v12, v12, v108
    v_sub_f32 v13, v13, v108
    v_sub_f32 v14, v14, v108
    v_sub_f32 v15, v15, v108
    v_sub_f32 v16, v16, v108
    v_sub_f32 v17, v17, v108
    v_sub_f32 v18, v18, v108
    v_sub_f32 v19, v19, v108
    v_sub_f32 v20, v20, v108
    v_sub_f32 v21, v21, v108
    v_sub_f32 v22, v22, v108
    v_sub_f32 v23, v23, v108
    v_sub_f32 v24, v24, v108
    v_sub_f32 v25, v25, v108
    v_sub_f32 v26, v26, v108
    v_sub_f32 v27, v27, v108
    v_sub_f32 v110, 0, v108
    v_exp_f32 v110, v110
    s_nop 0
    v_mul_f32 v28, v28, v110
    v_mul_f32 v29, v29, v110
    v_mul_f32 v30, v30, v110
    v_mul_f32 v31, v31, v110
    v_mul_f32 v32, v32, v110
    v_mul_f32 v33, v33, v110
    v_mul_f32 v34, v34, v110
    v_mul_f32 v35, v35, v110
    v_mul_f32 v36, v36, v110
    s_nop 1
    s_branch k2_attn_conv_kernel_cont17
k2_attn_conv_kernel_rare18:
    s_nop 15
    s_nop 15
    v_mov_b32 v110, v108
    v_mov_b32 v111, v108
    s_nop 1
    v_permlane32_swap_b32 v110, v111
    v_max_f32 v108, v110, v111
    v_max_f32 v108, 0, v108
    v_sub_f32 v60, v60, v108
    v_sub_f32 v61, v61, v108
    v_sub_f32 v62, v62, v108
    v_sub_f32 v63, v63, v108
    v_sub_f32 v64, v64, v108
    v_sub_f32 v65, v65, v108
    v_sub_f32 v66, v66, v108
    v_sub_f32 v67, v67, v108
    v_sub_f32 v68, v68, v108
    v_sub_f32 v69, v69, v108
    v_sub_f32 v70, v70, v108
    v_sub_f32 v71, v71, v108
    v_sub_f32 v72, v72, v108
    v_sub_f32 v73, v73, v108
    v_sub_f32 v74, v74, v108
    v_sub_f32 v75, v75, v108
    v_sub_f32 v12, v12, v108
    v_sub_f32 v13, v13, v108
    v_sub_f32 v14, v14, v108
    v_sub_f32 v15, v15, v108
    v_sub_f32 v16, v16, v108
    v_sub_f32 v17, v17, v108
    v_sub_f32 v18, v18, v108
    v_sub_f32 v19, v19, v108
    v_sub_f32 v20, v20, v108
    v_sub_f32 v21, v21, v108
    v_sub_f32 v22, v22, v108
    v_sub_f32 v23, v23, v108
    v_sub_f32 v24, v24, v108
    v_sub_f32 v25, v25, v108
    v_sub_f32 v26, v26, v108
    v_sub_f32 v27, v27, v108
    v_sub_f32 v110, 0, v108
    v_exp_f32 v110, v110
    s_nop 0
    v_mul_f32 v28, v28, v110
    v_mul_f32 v29, v29, v110
    v_mul_f32 v30, v30, v110
    v_mul_f32 v31, v31, v110
    v_mul_f32 v32, v32, v110
    v_mul_f32 v33, v33, v110
    v_mul_f32 v34, v34, v110
    v_mul_f32 v35, v35, v110
    v_mul_f32 v36, v36, v110
    s_nop 1
    s_branch k2_attn_conv_kernel_cont19
k2_attn_conv_kernel_conv1:
    s_mov_b32 s28, s6
    s_and_b32 s29, s7, 0xffff
    s_mov_b32 s30, 2097152
    s_mov_b32 s31, 0x00020000
    s_sub_u32 s26, s3, 8
    s_mul_i32 s27, s26, 14592
    s_add_u32 s27, s27, 131328
    s_lshl_b32 s16, s2, 1
    s_add_u32 s26, s26, s16
    s_lshl_b32 s16, s26, 1
    s_and_b32 s16, s16, 0xfffffffc
    s_load_dword s32, s[8:9], s16
    s_lshl_b32 s17, s26, 12
    s_add_u32 s17, s17, 6291456
    s_add_u32 s16, s17, 0
    s_add_u32 m0, s27, 0
    s_nop 0
    buffer_load_dwordx4 v4, s[12:15], s16 offen lds
    s_add_u32 s16, s17, 1024
    s_add_u32 m0, s27, 1024
    s_nop 0
    buffer_load_dwordx4 v4, s[12:15], s16 offen lds
    s_add_u32 s16, s17, 2048
    s_add_u32 m0, s27, 2048
    s_nop 0
    buffer_load_dwordx4 v4, s[12:15], s16 offen lds
    s_add_u32 s16, s17, 3072
    s_add_u32 m0, s27, 3072
    s_nop 0
    buffer_load_dwordx4 v4, s[12:15], s16 offen lds
    v_lshlrev_b32 v6, 6, v1
    s_lshl_b32 s16, s26, 12
    buffer_load_dwordx4 v[8:11], v6, s[28:31], s16 offen offset:0
    buffer_load_dwordx4 v[12:15], v6, s[28:31], s16 offen offset:16
    buffer_load_dwordx4 v[16:19], v6, s[28:31], s16 offen offset:32
    buffer_load_dwordx4 v[20:23], v6, s[28:31], s16 offen offset:48
    buffer_load_dword v5, v6, s[28:31], s16 offen offset:64
    s_barrier
    v_mov_b32 v24, 0
    v_mov_b32 v25, 0
    v_mov_b32 v26, 0
    v_mov_b32 v27, 0
    v_add_u32 v7, s27, v4
    ds_write_b128 v7, v[24:27] offset:4096
    ds_write_b128 v7, v[24:27] offset:5120
    s_waitcnt vmcnt(0) lgkmcnt(0)
    s_and_b32 s16, s26, 1
    s_lshl_b32 s16, s16, 4
    s_lshr_b32 s32, s32, s16
    s_lshl_b32 s32, s32, 16
    v_add_u32 v28, s27, v6
    ds_write_b128 v28, v[8:11] offset:6208
    ds_write_b128 v28, v[12:15] offset:6224
    ds_write_b128 v28, v[16:19] offset:6240
    ds_write_b128 v28, v[20:23] offset:6256
    v_alignbit_b32 v32, v9, v8, 16
    v_alignbit_b32 v33, v10, v9, 16
    v_alignbit_b32 v34, v11, v10, 16
    v_alignbit_b32 v35, v12, v11, 16
    v_alignbit_b32 v36, v13, v12, 16
    v_alignbit_b32 v37, v14, v13, 16
    v_alignbit_b32 v38, v15, v14, 16
    v_alignbit_b32 v39, v16, v15, 16
    v_alignbit_b32 v40, v17, v16, 16
    v_alignbit_b32 v41, v18, v17, 16
    v_alignbit_b32 v42, v19, v18, 16
    v_alignbit_b32 v43, v20, v19, 16
    v_alignbit_b32 v44, v21, v20, 16
    v_alignbit_b32 v45, v22, v21, 16
    v_alignbit_b32 v46, v23, v22, 16
    v_alignbit_b32 v47, v5, v23, 16
    ds_write_b128 v28, v[32:35] offset:10432
    ds_write_b128 v28, v[36:39] offset:10448
    ds_write_b128 v28, v[40:43] offset:10464
    ds_write_b128 v28, v[44:47] offset:10480
    s_mov_b64 exec, 1
    v_lshlrev_b32 v5, 16, v8
    v_mov_b32 v29, s27
    ds_write_b128 v29, v[24:27] offset:6144
    ds_write_b128 v29, v[24:27] offset:6160
    ds_write_b128 v29, v[24:27] offset:6176
    ds_write_b128 v29, v[24:27] offset:6192
    ds_write_b128 v29, v[24:27] offset:10368
    ds_write_b128 v29, v[24:27] offset:10384
    ds_write_b128 v29, v[24:27] offset:10400
    v_mov_b32 v27, v5
    ds_write_b128 v29, v[24:27] offset:10416
    s_mov_b64 exec, -1
    s_waitcnt lgkmcnt(0)
    s_barrier
    s_barrier
    v_lshlrev_b32 v5, 1, v2
    v_lshlrev_b32 v9, 4, v3
    v_sub_u32 v5, v5, v9
    v_and_b32 v9, 1, v2
    v_cmp_eq_u32 vcc, 1, v9
    v_mov_b32 v9, 10384
    v_mov_b32 v8, 6162
    v_cndmask_b32 v9, v9, v8, vcc
    v_add_u32 v5, v5, v9
    v_add_u32 v5, s27, v5
    v_lshlrev_b32 v8, 6, v2
    v_lshl_add_u32 v8, v3, 4, v8
    v_sub_u32 v8, 2000, v8
    v_add_u32 v8, s27, v8
    v_mov_b32 v28, 0
    v_mov_b32 v29, 0
    v_mov_b32 v30, 0
    v_mov_b32 v31, 0
    v_mov_b32 v32, 0
    v_mov_b32 v33, 0
    v_mov_b32 v34, 0
    v_mov_b32 v35, 0
    v_mov_b32 v36, 0
    v_mov_b32 v37, 0
    v_mov_b32 v38, 0
    v_mov_b32 v39, 0
    v_mov_b32 v40, 0
    v_mov_b32 v41, 0
    v_mov_b32 v42, 0
    v_mov_b32 v43, 0
    v_mov_b32 v44, 0
    v_mov_b32 v45, 0
    v_mov_b32 v46, 0
    v_mov_b32 v47, 0
    v_mov_b32 v48, 0
    v_mov_b32 v49, 0
    v_mov_b32 v50, 0
    v_mov_b32 v51, 0
    v_mov_b32 v52, 0
    v_mov_b32 v53, 0
    v_mov_b32 v54, 0
    v_mov_b32 v55, 0
    v_mov_b32 v56, 0
    v_mov_b32 v57, 0
    v_mov_b32 v58, 0
    v_mov_b32 v59, 0
    s_mov_b32 s33, 0
k2_attn_conv_kernel_cloop20:
    ds_read2_b32 v[12:13], v5 offset0:8 offset1:9
    ds_read2_b32 v[14:15], v5 offset0:10 offset1:11
    ds_read2_b32 v[16:17], v5 offset0:0 offset1:1
    ds_read2_b32 v[18:19], v5 offset0:2 offset1:3
    ds_read_b128 v[64:67], v8 offset:2080
    ds_read_b128 v[68:71], v8 offset:2048
    ds_read_b128 v[72:75], v8 offset:32
    ds_read_b128 v[76:79], v8 offset:0
    ds_read2_b32 v[20:21], v5 offset0:24 offset1:25
    ds_read2_b32 v[22:23], v5 offset0:26 offset1:27
    ds_read2_b32 v[60:61], v5 offset0:16 offset1:17
    ds_read2_b32 v[62:63], v5 offset0:18 offset1:19
    ds_read_b128 v[80:83], v8 offset:2144
    ds_read_b128 v[84:87], v8 offset:2112
    ds_read_b128 v[88:91], v8 offset:96
    ds_read_b128 v[92:95], v8 offset:64
    s_waitcnt lgkmcnt(8)
    v_mfma_f32_32x32x16_bf16 v[28:43], v[12:15], v[64:67], v[28:43]
    v_mfma_f32_32x32x16_bf16 v[28:43], v[16:19], v[68:71], v[28:43]
    v_mfma_f32_32x32x16_bf16 v[44:59], v[12:15], v[72:75], v[44:59]
    v_mfma_f32_32x32x16_bf16 v[44:59], v[16:19], v[76:79], v[44:59]
    ds_read2_b32 v[12:13], v5 offset0:40 offset1:41
    ds_read2_b32 v[14:15], v5 offset0:42 offset1:43
    ds_read2_b32 v[16:17], v5 offset0:32 offset1:33
    ds_read2_b32 v[18:19], v5 offset0:34 offset1:35
    ds_read_b128 v[64:67], v8 offset:2208
    ds_read_b128 v[68:71], v8 offset:2176
    ds_read_b128 v[72:75], v8 offset:160
    ds_read_b128 v[76:79], v8 offset:128
    s_waitcnt lgkmcnt(8)
    v_mfma_f32_32x32x16_bf16 v[28:43], v[20:23], v[80:83], v[28:43]
    v_mfma_f32_32x32x16_bf16 v[28:43], v[60:63], v[84:87], v[28:43]
    v_mfma_f32_32x32x16_bf16 v[44:59], v[20:23], v[88:91], v[44:59]
    v_mfma_f32_32x32x16_bf16 v[44:59], v[60:63], v[92:95], v[44:59]
    ds_read2_b32 v[20:21], v5 offset0:56 offset1:57
    ds_read2_b32 v[22:23], v5 offset0:58 offset1:59
    ds_read2_b32 v[60:61], v5 offset0:48 offset1:49
    ds_read2_b32 v[62:63], v5 offset0:50 offset1:51
    ds_read_b128 v[80:83], v8 offset:2272
    ds_read_b128 v[84:87], v8 offset:2240
    ds_read_b128 v[88:91], v8 offset:224
    ds_read_b128 v[92:95], v8 offset:192
    s_waitcnt lgkmcnt(8)
    v_mfma_f32_32x32x16_bf16 v[28:43], v[12:15], v[64:67], v[28:43]
    v_mfma_f32_32x32x16_bf16 v[28:43], v[16:19], v[68:71], v[28:43]
    v_mfma_f32_32x32x16_bf16 v[44:59], v[12:15], v[72:75], v[44:59]
    v_mfma_f32_32x32x16_bf16 v[44:59], v[16:19], v[76:79], v[44:59]
    ds_read2_b32 v[12:13], v5 offset0:72 offset1:73
    ds_read2_b32 v[14:15], v5 offset0:74 offset1:75
    ds_read2_b32 v[16:17], v5 offset0:64 offset1:65
    ds_read2_b32 v[18:19], v5 offset0:66 offset1:67
    ds_read_b128 v[64:67], v8 offset:2336
    ds_read_b128 v[68:71], v8 offset:2304
    ds_read_b128 v[72:75], v8 offset:288
    ds_read_b128 v[76:79], v8 offset:256
    s_waitcnt lgkmcnt(8)
    v_mfma_f32_32x32x16_bf16 v[28:43], v[20:23], v[80:83], v[28:43]
    v_mfma_f32_32x32x16_bf16 v[28:43], v[60:63], v[84:87], v[28:43]
    v_mfma_f32_32x32x16_bf16 v[44:59], v[20:23], v[88:91], v[44:59]
    v_mfma_f32_32x32x16_bf16 v[44:59], v[60:63], v[92:95], v[44:59]
    ds_read2_b32 v[20:21], v5 offset0:88 offset1:89
    ds_read2_b32 v[22:23], v5 offset0:90 offset1:91
    ds_read2_b32 v[60:61], v5 offset0:80 offset1:81
    ds_read2_b32 v[62:63], v5 offset0:82 offset1:83
    ds_read_b128 v[80:83], v8 offset:2400
    ds_read_b128 v[84:87], v8 offset:2368
    ds_read_b128 v[88:91], v8 offset:352
    ds_read_b128 v[92:95], v8 offset:320
    s_waitcnt lgkmcnt(8)
    v_mfma_f32_32x32x16_bf16 v[28:43], v[12:15], v[64:67], v[28:43]
    v_mfma_f32_32x32x16_bf16 v[28:43], v[16:19], v[68:71], v[28:43]
    v_mfma_f32_32x32x16_bf16 v[44:59], v[12:15], v[72:75], v[44:59]
    v_mfma_f32_32x32x16_bf16 v[44:59], v[16:19], v[76:79], v[44:59]
    ds_read2_b32 v[12:13], v5 offset0:104 offset1:105
    ds_read2_b32 v[14:15], v5 offset0:106 offset1:107
    ds_read2_b32 v[16:17], v5 offset0:96 offset1:97
    ds_read2_b32 v[18:19], v5 offset0:98 offset1:99
    ds_read_b128 v[64:67], v8 offset:2464
    ds_read_b128 v[68:71], v8 offset:2432
    ds_read_b128 v[72:75], v8 offset:416
    ds_read_b128 v[76:79], v8 offset:384
    s_waitcnt lgkmcnt(8)
    v_mfma_f32_32x32x16_bf16 v[28:43], v[20:23], v[80:83], v[28:43]
    v_mfma_f32_32x32x16_bf16 v[28:43], v[60:63], v[84:87], v[28:43]
    v_mfma_f32_32x32x16_bf16 v[44:59], v[20:23], v[88:91], v[44:59]
    v_mfma_f32_32x32x16_bf16 v[44:59], v[60:63], v[92:95], v[44:59]
    ds_read2_b32 v[20:21], v5 offset0:120 offset1:121
    ds_read2_b32 v[22:23], v5 offset0:122 offset1:123
    ds_read2_b32 v[60:61], v5 offset0:112 offset1:113
    ds_read2_b32 v[62:63], v5 offset0:114 offset1:115
    ds_read_b128 v[80:83], v8 offset:2528
    ds_read_b128 v[84:87], v8 offset:2496
    ds_read_b128 v[88:91], v8 offset:480
    ds_read_b128 v[92:95], v8 offset:448
    s_waitcnt lgkmcnt(8)
    v_mfma_f32_32x32x16_bf16 v[28:43], v[12:15], v[64:67], v[28:43]
    v_mfma_f32_32x32x16_bf16 v[28:43], v[16:19], v[68:71], v[28:43]
    v_mfma_f32_32x32x16_bf16 v[44:59], v[12:15], v[72:75], v[44:59]
    v_mfma_f32_32x32x16_bf16 v[44:59], v[16:19], v[76:79], v[44:59]
    s_waitcnt lgkmcnt(0)
    v_mfma_f32_32x32x16_bf16 v[28:43], v[20:23], v[80:83], v[28:43]
    v_mfma_f32_32x32x16_bf16 v[28:43], v[60:63], v[84:87], v[28:43]
    v_mfma_f32_32x32x16_bf16 v[44:59], v[20:23], v[88:91], v[44:59]
    v_mfma_f32_32x32x16_bf16 v[44:59], v[60:63], v[92:95], v[44:59]
    v_add_u32 v5, 512, v5
    v_add_u32 v8, 512, v8
    s_add_u32 s33, s33, 1
    s_cmp_lt_u32 s33, 4
    s_cbranch_scc1 k2_attn_conv_kernel_cloop20
    s_mov_b32 s33, 0
k2_attn_conv_kernel_cloop21:
    ds_read2_b32 v[12:13], v5 offset0:8 offset1:9
    ds_read2_b32 v[14:15], v5 offset0:10 offset1:11
    ds_read2_b32 v[16:17], v5 offset0:0 offset1:1
    ds_read2_b32 v[18:19], v5 offset0:2 offset1:3
    ds_read_b128 v[72:75], v8 offset:32
    ds_read_b128 v[76:79], v8 offset:0
    ds_read2_b32 v[20:21], v5 offset0:24 offset1:25
    ds_read2_b32 v[22:23], v5 offset0:26 offset1:27
    ds_read2_b32 v[60:61], v5 offset0:16 offset1:17
    ds_read2_b32 v[62:63], v5 offset0:18 offset1:19
    ds_read_b128 v[88:91], v8 offset:96
    ds_read_b128 v[92:95], v8 offset:64
    s_waitcnt lgkmcnt(6)
    v_mfma_f32_32x32x16_bf16 v[44:59], v[12:15], v[72:75], v[44:59]
    v_mfma_f32_32x32x16_bf16 v[44:59], v[16:19], v[76:79], v[44:59]
    ds_read2_b32 v[12:13], v5 offset0:40 offset1:41
    ds_read2_b32 v[14:15], v5 offset0:42 offset1:43
    ds_read2_b32 v[16:17], v5 offset0:32 offset1:33
    ds_read2_b32 v[18:19], v5 offset0:34 offset1:35
    ds_read_b128 v[72:75], v8 offset:160
    ds_read_b128 v[76:79], v8 offset:128
    s_waitcnt lgkmcnt(6)
    v_mfma_f32_32x32x16_bf16 v[44:59], v[20:23], v[88:91], v[44:59]
    v_mfma_f32_32x32x16_bf16 v[44:59], v[60:63], v[92:95], v[44:59]
    ds_read2_b32 v[20:21], v5 offset0:56 offset1:57
    ds_read2_b32 v[22:23], v5 offset0:58 offset1:59
    ds_read2_b32 v[60:61], v5 offset0:48 offset1:49
    ds_read2_b32 v[62:63], v5 offset0:50 offset1:51
    ds_read_b128 v[88:91], v8 offset:224
    ds_read_b128 v[92:95], v8 offset:192
    s_waitcnt lgkmcnt(6)
    v_mfma_f32_32x32x16_bf16 v[44:59], v[12:15], v[72:75], v[44:59]
    v_mfma_f32_32x32x16_bf16 v[44:59], v[16:19], v[76:79], v[44:59]
    ds_read2_b32 v[12:13], v5 offset0:72 offset1:73
    ds_read2_b32 v[14:15], v5 offset0:74 offset1:75
    ds_read2_b32 v[16:17], v5 offset0:64 offset1:65
    ds_read2_b32 v[18:19], v5 offset0:66 offset1:67
    ds_read_b128 v[72:75], v8 offset:288
    ds_read_b128 v[76:79], v8 offset:256
    s_waitcnt lgkmcnt(6)
    v_mfma_f32_32x32x16_bf16 v[44:59], v[20:23], v[88:91], v[44:59]
    v_mfma_f32_32x32x16_bf16 v[44:59], v[60:63], v[92:95], v[44:59]
    ds_read2_b32 v[20:21], v5 offset0:88 offset1:89
    ds_read2_b32 v[22:23], v5 offset0:90 offset1:91
    ds_read2_b32 v[60:61], v5 offset0:80 offset1:81
    ds_read2_b32 v[62:63], v5 offset0:82 offset1:83
    ds_read_b128 v[88:91], v8 offset:352
    ds_read_b128 v[92:95], v8 offset:320
    s_waitcnt lgkmcnt(6)
    v_mfma_f32_32x32x16_bf16 v[44:59], v[12:15], v[72:75], v[44:59]
    v_mfma_f32_32x32x16_bf16 v[44:59], v[16:19], v[76:79], v[44:59]
    ds_read2_b32 v[12:13], v5 offset0:104 offset1:105
    ds_read2_b32 v[14:15], v5 offset0:106 offset1:107
    ds_read2_b32 v[16:17], v5 offset0:96 offset1:97
    ds_read2_b32 v[18:19], v5 offset0:98 offset1:99
    ds_read_b128 v[72:75], v8 offset:416
    ds_read_b128 v[76:79], v8 offset:384
    s_waitcnt lgkmcnt(6)
    v_mfma_f32_32x32x16_bf16 v[44:59], v[20:23], v[88:91], v[44:59]
    v_mfma_f32_32x32x16_bf16 v[44:59], v[60:63], v[92:95], v[44:59]
    ds_read2_b32 v[20:21], v5 offset0:120 offset1:121
    ds_read2_b32 v[22:23], v5 offset0:122 offset1:123
    ds_read2_b32 v[60:61], v5 offset0:112 offset1:113
    ds_read2_b32 v[62:63], v5 offset0:114 offset1:115
    ds_read_b128 v[88:91], v8 offset:480
    ds_read_b128 v[92:95], v8 offset:448
    s_waitcnt lgkmcnt(6)
    v_mfma_f32_32x32x16_bf16 v[44:59], v[12:15], v[72:75], v[44:59]
    v_mfma_f32_32x32x16_bf16 v[44:59], v[16:19], v[76:79], v[44:59]
    s_waitcnt lgkmcnt(0)
    v_mfma_f32_32x32x16_bf16 v[44:59], v[20:23], v[88:91], v[44:59]
    v_mfma_f32_32x32x16_bf16 v[44:59], v[60:63], v[92:95], v[44:59]
    v_add_u32 v5, 512, v5
    v_add_u32 v8, 512, v8
    s_add_u32 s33, s33, 1
    s_cmp_lt_u32 s33, 4
    s_cbranch_scc1 k2_attn_conv_kernel_cloop21
    s_nop 6
    v_lshlrev_b32 v10, 6, v2
    v_lshl_add_u32 v10, v3, 3, v10
    v_sub_u32 v10, 1992, v10
    v_add_u32 v10, s27, v10
    v_lshlrev_b32 v11, 6, v2
    v_lshl_add_u32 v11, v3, 3, v11
    s_lshl_b32 s17, s26, 12
    s_add_u32 s17, s17, 8388608
    ds_read_b64 v[96:97], v10 offset:2096
    v_cvt_pk_bf16_f32 v102, v28, v29
    v_lshlrev_b32 v28, 16, v102
    v_and_b32 v29, 0xffff0000, v102
    v_cvt_pk_bf16_f32 v102, v30, v31
    v_lshlrev_b32 v30, 16, v102
    v_and_b32 v31, 0xffff0000, v102
    s_waitcnt lgkmcnt(0)
    v_lshlrev_b32 v101, 16, v96
    v_and_b32 v100, 0xffff0000, v96
    v_lshlrev_b32 v99, 16, v97
    v_and_b32 v98, 0xffff0000, v97
    v_mul_f32 v98, s32, v98
    v_mul_f32 v99, s32, v99
    v_mul_f32 v100, s32, v100
    v_mul_f32 v101, s32, v101
    v_cvt_pk_bf16_f32 v102, v98, v99
    v_lshlrev_b32 v98, 16, v102
    v_and_b32 v99, 0xffff0000, v102
    v_cvt_pk_bf16_f32 v102, v100, v101
    v_lshlrev_b32 v100, 16, v102
    v_and_b32 v101, 0xffff0000, v102
    v_add_f32 v28, v28, v98
    v_add_f32 v29, v29, v99
    v_add_f32 v30, v30, v100
    v_add_f32 v31, v31, v101
    v_cvt_pk_bf16_f32 v104, v28, v29
    v_cvt_pk_bf16_f32 v105, v30, v31
    s_add_u32 s16, s17, 0
    buffer_store_dwordx2 v[104:105], v11, s[12:15], s16 offen
    ds_read_b64 v[96:97], v10 offset:2080
    v_cvt_pk_bf16_f32 v102, v32, v33
    v_lshlrev_b32 v32, 16, v102
    v_and_b32 v33, 0xffff0000, v102
    v_cvt_pk_bf16_f32 v102, v34, v35
    v_lshlrev_b32 v34, 16, v102
    v_and_b32 v35, 0xffff0000, v102
    s_waitcnt lgkmcnt(0)
    v_lshlrev_b32 v101, 16, v96
    v_and_b32 v100, 0xffff0000, v96
    v_lshlrev_b32 v99, 16, v97
    v_and_b32 v98, 0xffff0000, v97
    v_mul_f32 v98, s32, v98
    v_mul_f32 v99, s32, v99
    v_mul_f32 v100, s32, v100
    v_mul_f32 v101, s32, v101
    v_cvt_pk_bf16_f32 v102, v98, v99
    v_lshlrev_b32 v98, 16, v102
    v_and_b32 v99, 0xffff0000, v102
    v_cvt_pk_bf16_f32 v102, v100, v101
    v_lshlrev_b32 v100, 16, v102
    v_and_b32 v101, 0xffff0000, v102
    v_add_f32 v32, v32, v98
    v_add_f32 v33, v33, v99
    v_add_f32 v34, v34, v100
    v_add_f32 v35, v35, v101
    v_cvt_pk_bf16_f32 v104, v32, v33
    v_cvt_pk_bf16_f32 v105, v34, v35
    s_add_u32 s16, s17, 16
    buffer_store_dwordx2 v[104:105], v11, s[12:15], s16 offen
    ds_read_b64 v[96:97], v10 offset:2064
    v_cvt_pk_bf16_f32 v102, v36, v37
    v_lshlrev_b32 v36, 16, v102
    v_and_b32 v37, 0xffff0000, v102
    v_cvt_pk_bf16_f32 v102, v38, v39
    v_lshlrev_b32 v38, 16, v102
    v_and_b32 v39, 0xffff0000, v102
    s_waitcnt lgkmcnt(0)
    v_lshlrev_b32 v101, 16, v96
    v_and_b32 v100, 0xffff0000, v96
    v_lshlrev_b32 v99, 16, v97
    v_and_b32 v98, 0xffff0000, v97
    v_mul_f32 v98, s32, v98
    v_mul_f32 v99, s32, v99
    v_mul_f32 v100, s32, v100
    v_mul_f32 v101, s32, v101
    v_cvt_pk_bf16_f32 v102, v98, v99
    v_lshlrev_b32 v98, 16, v102
    v_and_b32 v99, 0xffff0000, v102
    v_cvt_pk_bf16_f32 v102, v100, v101
    v_lshlrev_b32 v100, 16, v102
    v_and_b32 v101, 0xffff0000, v102
    v_add_f32 v36, v36, v98
    v_add_f32 v37, v37, v99
    v_add_f32 v38, v38, v100
    v_add_f32 v39, v39, v101
    v_cvt_pk_bf16_f32 v104, v36, v37
    v_cvt_pk_bf16_f32 v105, v38, v39
    s_add_u32 s16, s17, 32
    buffer_store_dwordx2 v[104:105], v11, s[12:15], s16 offen
    ds_read_b64 v[96:97], v10 offset:2048
    v_cvt_pk_bf16_f32 v102, v40, v41
    v_lshlrev_b32 v40, 16, v102
    v_and_b32 v41, 0xffff0000, v102
    v_cvt_pk_bf16_f32 v102, v42, v43
    v_lshlrev_b32 v42, 16, v102
    v_and_b32 v43, 0xffff0000, v102
    s_waitcnt lgkmcnt(0)
    v_lshlrev_b32 v101, 16, v96
    v_and_b32 v100, 0xffff0000, v96
    v_lshlrev_b32 v99, 16, v97
    v_and_b32 v98, 0xffff0000, v97
    v_mul_f32 v98, s32, v98
    v_mul_f32 v99, s32, v99
    v_mul_f32 v100, s32, v100
    v_mul_f32 v101, s32, v101
    v_cvt_pk_bf16_f32 v102, v98, v99
    v_lshlrev_b32 v98, 16, v102
    v_and_b32 v99, 0xffff0000, v102
    v_cvt_pk_bf16_f32 v102, v100, v101
    v_lshlrev_b32 v100, 16, v102
    v_and_b32 v101, 0xffff0000, v102
    v_add_f32 v40, v40, v98
    v_add_f32 v41, v41, v99
    v_add_f32 v42, v42, v100
    v_add_f32 v43, v43, v101
    v_cvt_pk_bf16_f32 v104, v40, v41
    v_cvt_pk_bf16_f32 v105, v42, v43
    s_add_u32 s16, s17, 48
    buffer_store_dwordx2 v[104:105], v11, s[12:15], s16 offen
    ds_read_b64 v[96:97], v10 offset:48
    v_cvt_pk_bf16_f32 v102, v44, v45
    v_lshlrev_b32 v44, 16, v102
    v_and_b32 v45, 0xffff0000, v102
    v_cvt_pk_bf16_f32 v102, v46, v47
    v_lshlrev_b32 v46, 16, v102
    v_and_b32 v47, 0xffff0000, v102
    s_waitcnt lgkmcnt(0)
    v_lshlrev_b32 v101, 16, v96
    v_and_b32 v100, 0xffff0000, v96
    v_lshlrev_b32 v99, 16, v97
    v_and_b32 v98, 0xffff0000, v97
    v_mul_f32 v98, s32, v98
    v_mul_f32 v99, s32, v99
    v_mul_f32 v100, s32, v100
    v_mul_f32 v101, s32, v101
    v_cvt_pk_bf16_f32 v102, v98, v99
    v_lshlrev_b32 v98, 16, v102
    v_and_b32 v99, 0xffff0000, v102
    v_cvt_pk_bf16_f32 v102, v100, v101
    v_lshlrev_b32 v100, 16, v102
    v_and_b32 v101, 0xffff0000, v102
    v_add_f32 v44, v44, v98
    v_add_f32 v45, v45, v99
    v_add_f32 v46, v46, v100
    v_add_f32 v47, v47, v101
    v_cvt_pk_bf16_f32 v104, v44, v45
    v_cvt_pk_bf16_f32 v105, v46, v47
    s_add_u32 s16, s17, 2048
    buffer_store_dwordx2 v[104:105], v11, s[12:15], s16 offen
    ds_read_b64 v[96:97], v10 offset:32
    v_cvt_pk_bf16_f32 v102, v48, v49
    v_lshlrev_b32 v48, 16, v102
    v_and_b32 v49, 0xffff0000, v102
    v_cvt_pk_bf16_f32 v102, v50, v51
    v_lshlrev_b32 v50, 16, v102
    v_and_b32 v51, 0xffff0000, v102
    s_waitcnt lgkmcnt(0)
    v_lshlrev_b32 v101, 16, v96
    v_and_b32 v100, 0xffff0000, v96
    v_lshlrev_b32 v99, 16, v97
    v_and_b32 v98, 0xffff0000, v97
    v_mul_f32 v98, s32, v98
    v_mul_f32 v99, s32, v99
    v_mul_f32 v100, s32, v100
    v_mul_f32 v101, s32, v101
    v_cvt_pk_bf16_f32 v102, v98, v99
    v_lshlrev_b32 v98, 16, v102
    v_and_b32 v99, 0xffff0000, v102
    v_cvt_pk_bf16_f32 v102, v100, v101
    v_lshlrev_b32 v100, 16, v102
    v_and_b32 v101, 0xffff0000, v102
    v_add_f32 v48, v48, v98
    v_add_f32 v49, v49, v99
    v_add_f32 v50, v50, v100
    v_add_f32 v51, v51, v101
    v_cvt_pk_bf16_f32 v104, v48, v49
    v_cvt_pk_bf16_f32 v105, v50, v51
    s_add_u32 s16, s17, 2064
    buffer_store_dwordx2 v[104:105], v11, s[12:15], s16 offen
    ds_read_b64 v[96:97], v10 offset:16
    v_cvt_pk_bf16_f32 v102, v52, v53
    v_lshlrev_b32 v52, 16, v102
    v_and_b32 v53, 0xffff0000, v102
    v_cvt_pk_bf16_f32 v102, v54, v55
    v_lshlrev_b32 v54, 16, v102
    v_and_b32 v55, 0xffff0000, v102
    s_waitcnt lgkmcnt(0)
    v_lshlrev_b32 v101, 16, v96
    v_and_b32 v100, 0xffff0000, v96
    v_lshlrev_b32 v99, 16, v97
    v_and_b32 v98, 0xffff0000, v97
    v_mul_f32 v98, s32, v98
    v_mul_f32 v99, s32, v99
    v_mul_f32 v100, s32, v100
    v_mul_f32 v101, s32, v101
    v_cvt_pk_bf16_f32 v102, v98, v99
    v_lshlrev_b32 v98, 16, v102
    v_and_b32 v99, 0xffff0000, v102
    v_cvt_pk_bf16_f32 v102, v100, v101
    v_lshlrev_b32 v100, 16, v102
    v_and_b32 v101, 0xffff0000, v102
    v_add_f32 v52, v52, v98
    v_add_f32 v53, v53, v99
    v_add_f32 v54, v54, v100
    v_add_f32 v55, v55, v101
    v_cvt_pk_bf16_f32 v104, v52, v53
    v_cvt_pk_bf16_f32 v105, v54, v55
    s_add_u32 s16, s17, 2080
    buffer_store_dwordx2 v[104:105], v11, s[12:15], s16 offen
    ds_read_b64 v[96:97], v10 offset:0
    v_cvt_pk_bf16_f32 v102, v56, v57
    v_lshlrev_b32 v56, 16, v102
    v_and_b32 v57, 0xffff0000, v102
    v_cvt_pk_bf16_f32 v102, v58, v59
    v_lshlrev_b32 v58, 16, v102
    v_and_b32 v59, 0xffff0000, v102
    s_waitcnt lgkmcnt(0)
    v_lshlrev_b32 v101, 16, v96
    v_and_b32 v100, 0xffff0000, v96
    v_lshlrev_b32 v99, 16, v97
    v_and_b32 v98, 0xffff0000, v97
    v_mul_f32 v98, s32, v98
    v_mul_f32 v99, s32, v99
    v_mul_f32 v100, s32, v100
    v_mul_f32 v101, s32, v101
    v_cvt_pk_bf16_f32 v102, v98, v99
    v_lshlrev_b32 v98, 16, v102
    v_and_b32 v99, 0xffff0000, v102
    v_cvt_pk_bf16_f32 v102, v100, v101
    v_lshlrev_b32 v100, 16, v102
    v_and_b32 v101, 0xffff0000, v102
    v_add_f32 v56, v56, v98
    v_add_f32 v57, v57, v99
    v_add_f32 v58, v58, v100
    v_add_f32 v59, v59, v101
    v_cvt_pk_bf16_f32 v104, v56, v57
    v_cvt_pk_bf16_f32 v105, v58, v59
    s_add_u32 s16, s17, 2096
    buffer_store_dwordx2 v[104:105], v11, s[12:15], s16 offen
k2_attn_conv_kernel_end2:
    s_endpgm
.section .rodata,"a"
.p2align 6
.amdhsa_kernel k2_attn_conv_kernel
  .amdhsa_next_free_vgpr 115
  .amdhsa_next_free_sgpr 34
  .amdhsa_accum_offset 116
  .amdhsa_group_segment_fixed_size 0
  .amdhsa_kernarg_size 104
  .amdhsa_user_sgpr_count 2
  .amdhsa_user_sgpr_kernarg_segment_ptr 1
  .amdhsa_system_sgpr_workgroup_id_x 1
  .amdhsa_float_denorm_mode_32 3
  .amdhsa_float_denorm_mode_16_64 3
.end_amdhsa_kernel
.text
.globl k3_outproj_mix_kernel
.p2align 8
.type k3_outproj_mix_kernel,@function
k3_outproj_mix_kernel:
    s_cmp_ge_u32 s2, 256
    s_cbranch_scc1 k3_outproj_mix_kernel_end1
    s_load_dwordx2 s[4:5], s[0:1], 96
    s_load_dwordx2 s[6:7], s[0:1], 64
    s_load_dwordx2 s[8:9], s[0:1], 0
    s_load_dwordx2 s[10:11], s[0:1], 80
    v_lshrrev_b32 v1, 6, v0
    s_nop 0
    v_readfirstlane_b32 s3, v1
    v_and_b32 v1, 63, v0
    s_waitcnt lgkmcnt(0)
    s_mov_b32 s12, s4
    s_and_b32 s13, s5, 0xffff
    s_mov_b32 s14, 12648448
    s_mov_b32 s15, 0x00020000
    s_mov_b32 s16, s6
    s_and_b32 s17, s7, 0xffff
    s_mov_b32 s18, 524288
    s_mov_b32 s19, 0x00020000
    s_mov_b32 s20, s8
    s_and_b32 s21, s9, 0xffff
    s_mov_b32 s22, 2097152
    s_mov_b32 s23, 0x00020000
    s_mov_b32 s24, s10
    s_and_b32 s25, s11, 0xffff
    s_mov_b32 s26, 2097152
    s_mov_b32 s27, 0x00020000
    s_and_b32 s28, s2, 31
    s_lshl_b32 s28, s28, 6
    s_lshr_b32 s29, s2, 5
    s_lshl_b32 s29, s29, 6
    s_lshl_b32 s30, s28, 10
    s_add_u32 s30, s30, 10485760
    s_lshl_b32 s31, s29, 1
    v_and_b32 v2, 31, v1
    v_lshrrev_b32 v3, 5, v1
    s_lshr_b32 s33, s3, 1
    s_and_b32 s34, s3, 1
    s_lshl_b32 s35, s33, 5
    s_add_u32 s35, s35, s28
    s_lshl_b32 s36, s34, 5
    s_add_u32 s36, s36, s29
    v_lshlrev_b32 v4, 10, v2
    v_lshl_add_u32 v4, v3, 3, v4
    v_lshlrev_b32 v5, 14, v3
    v_lshl_add_u32 v5, v2, 1, v5
    v_lshlrev_b32 v6, 2, v2
    s_lshl_b32 s37, s35, 10
    s_lshl_b32 s32, s36, 1
    s_add_u32 s37, s37, s32
    s_lshl_b32 s38, s36, 12
    s_lshl_b32 s32, s35, 1
    s_add_u32 s38, s38, s32
    s_add_u32 s38, s38, 8388608
    buffer_load_dwordx2 v[8:9], v4, s[20:23], s37 offen offset:0
    buffer_load_dwordx2 v[10:11], v4, s[20:23], s37 offen offset:16
    buffer_load_dwordx2 v[12:13], v4, s[20:23], s37 offen offset:32
    buffer_load_dwordx2 v[14:15], v4, s[20:23], s37 offen offset:48
    s_add_u32 s32, s38, 0
    buffer_load_ushort v16, v5, s[12:15], s32 offen
    s_add_u32 s32, s38, 4096
    buffer_load_ushort v17, v5, s[12:15], s32 offen
    s_add_u32 s32, s38, 8192
    buffer_load_ushort v18, v5, s[12:15], s32 offen
    s_add_u32 s32, s38, 12288
    buffer_load_ushort v19, v5, s[12:15], s32 offen
    s_add_u32 s32, s38, 32768
    buffer_load_ushort v20, v5, s[12:15], s32 offen
    s_add_u32 s32, s38, 36864
    buffer_load_ushort v21, v5, s[12:15], s32 offen
    s_add_u32 s32, s38, 40960
    buffer_load_ushort v22, v5, s[12:15], s32 offen
    s_add_u32 s32, s38, 45056
    buffer_load_ushort v23, v5, s[12:15], s32 offen
    s_add_u32 s32, s38, 65536
    buffer_load_ushort v24, v5, s[12:15], s32 offen
    s_add_u32 s32, s38, 69632
    buffer_load_ushort v25, v5, s[12:15], s32 offen
    s_add_u32 s32, s38, 73728
    buffer_load_ushort v26, v5, s[12:15], s32 offen
    s_add_u32 s32, s38, 77824
    buffer_load_ushort v27, v5, s[12:15], s32 offen
    s_add_u32 s32, s38, 98304
    buffer_load_ushort v28, v5, s[12:15], s32 offen
    s_add_u32 s32, s38, 102400
    buffer_load_ushort v29, v5, s[12:15], s32 offen
    s_add_u32 s32, s38, 106496
    buffer_load_ushort v30, v5, s[12:15], s32 offen
    s_add_u32 s32, s38, 110592
    buffer_load_ushort v31, v5, s[12:15], s32 offen
    s_lshl_b32 s32, s35, 2
    s_add_u32 s32, s32, 12582912
    buffer_load_dword v7, v6, s[12:15], s32 offen
    s_lshr_b32 s39, s3, 1
    s_and_b32 s40, s3, 1
    v_lshrrev_b32 v35, 4, v1
    v_and_b32 v35, 7, v35
    v_and_b32 v36, 7, v1
    v_xor_b32 v35, v35, v36
    v_lshlrev_b32 v35, 4, v35
    v_lshrrev_b32 v36, 3, v1
    v_lshl_add_u32 v32, v36, 10, v35
    v_lshrrev_b32 v35, 4, v1
    v_add_u32 v35, 4, v35
    v_and_b32 v35, 7, v35
    v_and_b32 v36, 7, v1
    v_xor_b32 v35, v35, v36
    v_lshlrev_b32 v35, 4, v35
    v_lshrrev_b32 v36, 3, v1
    v_lshl_add_u32 v33, v36, 10, v35
    v_lshrrev_b32 v35, 3, v1
    v_lshrrev_b32 v36, 4, v1
    v_and_b32 v36, 1, v36
    v_lshlrev_b32 v36, 2, v36
    v_and_b32 v34, 7, v1
    v_xor_b32 v34, v34, v36
    v_lshlrev_b32 v34, 4, v34
    s_mov_b32 s41, 1024
    v_mul_lo_u32 v35, v35, s41
    v_add_u32 v34, v34, v35
    s_mul_i32 s42, s3, 16384
    s_add_u32 s42, s42, s30
    s_mul_i32 s43, s3, 16384
    s_add_u32 s43, s43, s31
    s_lshl_b32 s44, s3, 11
    v_and_b32 v42, 31, v1
    v_lshrrev_b32 v43, 5, v1
    v_lshrrev_b32 v35, 1, v1
    v_and_b32 v35, 7, v35
    s_mul_i32 s45, s39, 4096
    s_add_u32 s45, s45, 0
    v_add_u32 v36, 0, v43
    v_xor_b32 v36, v36, v35
    v_lshlrev_b32 v36, 4, v36
    v_lshl_add_u32 v37, v42, 7, v36
    v_add_u32 v37, s45, v37
    v_add_u32 v36, 2, v43
    v_xor_b32 v36, v36, v35
    v_lshlrev_b32 v36, 4, v36
    v_lshl_add_u32 v38, v42, 7, v36
    v_add_u32 v38, s45, v38
    v_add_u32 v36, 4, v43
    v_xor_b32 v36, v36, v35
    v_lshlrev_b32 v36, 4, v36
    v_lshl_add_u32 v39, v42, 7, v36
    v_add_u32 v39, s45, v39
    v_add_u32 v36, 6, v43
    v_xor_b32 v36, v36, v35
    v_lshlrev_b32 v36, 4, v36
    v_lshl_add_u32 v40, v42, 7, v36
    v_add_u32 v40, s45, v40
    v_lshrrev_b32 v44, 4, v1
    v_and_b32 v46, 15, v1
    v_lshrrev_b32 v45, 2, v46
    v_and_b32 v46, 3, v46
    v_and_b32 v47, 1, v44
    v_lshlrev_b32 v47, 1, v47
    v_lshrrev_b32 v35, 1, v46
    v_add_u32 v47, v47, v35
    v_lshrrev_b32 v35, 1, v45
    v_xor_b32 v35, s40, v35
    v_lshl_add_u32 v35, v35, 2, v47
    v_lshlrev_b32 v35, 4, v35
    v_and_b32 v36, 1, v46
    v_lshl_add_u32 v35, v36, 3, v35
    v_lshrrev_b32 v36, 1, v44
    v_lshl_add_u32 v36, v36, 3, v45
    v_mul_u32_u24 v36, 128, v36
    v_add_u32 v41, v35, v36
    v_add_u32 v41, 8192, v41
    v_mov_b32 v44, 0
    v_mov_b32 v45, 0
    v_mov_b32 v46, 0
    v_mov_b32 v47, 0
    v_mov_b32 v48, 0
    v_mov_b32 v49, 0
    v_mov_b32 v50, 0
    v_mov_b32 v51, 0
    v_mov_b32 v52, 0
    v_mov_b32 v53, 0
    v_mov_b32 v54, 0
    v_mov_b32 v55, 0
    v_mov_b32 v56, 0
    v_mov_b32 v57, 0
    v_mov_b32 v58, 0
    v_mov_b32 v59, 0
    s_add_u32 s45, s42, 0
    s_add_u32 m0, s44, 0
    s_nop 0
    buffer_load_dwordx4 v32, s[12:15], s45 offen lds
    s_add_u32 s45, s42, 8192
    s_add_u32 m0, s44, 1024
    s_nop 0
    buffer_load_dwordx4 v33, s[12:15], s45 offen lds
    s_add_u32 s45, s43, 0
    s_add_u32 m0, s44, 8192
    s_nop 0
    buffer_load_dwordx4 v34, s[16:19], s45 offen lds
    s_add_u32 s45, s43, 8192
    s_add_u32 m0, s44, 9216
    s_nop 0
    buffer_load_dwordx4 v34, s[16:19], s45 offen lds
    s_add_u32 s45, s42, 128
    s_add_u32 m0, s44, 16384
    s_nop 0
    buffer_load_dwordx4 v32, s[12:15], s45 offen lds
    s_add_u32 s45, s42, 8320
    s_add_u32 m0, s44, 17408
    s_nop 0
    buffer_load_dwordx4 v33, s[12:15], s45 offen lds
    s_add_u32 s45, s43, 65536
    s_add_u32 m0, s44, 24576
    s_nop 0
    buffer_load_dwordx4 v34, s[16:19], s45 offen lds
    s_add_u32 s45, s43, 73728
    s_add_u32 m0, s44, 25600
    s_nop 0
    buffer_load_dwordx4 v34, s[16:19], s45 offen lds
    s_add_u32 s45, s42, 256
    s_add_u32 m0, s44, 32768
    s_nop 0
    buffer_load_dwordx4 v32, s[12:15], s45 offen lds
    s_add_u32 s45, s42, 8448
    s_add_u32 m0, s44, 33792
    s_nop 0
    buffer_load_dwordx4 v33, s[12:15], s45 offen lds
    s_add_u32 s45, s43, 131072
    s_add_u32 m0, s44, 40960
    s_nop 0
    buffer_load_dwordx4 v34, s[16:19], s45 offen lds
    s_add_u32 s45, s43, 139264
    s_add_u32 m0, s44, 41984
    s_nop 0
    buffer_load_dwordx4 v34, s[16:19], s45 offen lds
    s_add_u32 s45, s42, 384
    s_add_u32 m0, s44, 49152
    s_nop 0
    buffer_load_dwordx4 v32, s[12:15], s45 offen lds
    s_add_u32 s45, s42, 8576
    s_add_u32 m0, s44, 50176
    s_nop 0
    buffer_load_dwordx4 v33, s[12:15], s45 offen lds
    s_add_u32 s45, s43, 196608
    s_add_u32 m0, s44, 57344
    s_nop 0
    buffer_load_dwordx4 v34, s[16:19], s45 offen lds
    s_add_u32 s45, s43, 204800
    s_add_u32 m0, s44, 58368
    s_nop 0
    buffer_load_dwordx4 v34, s[16:19], s45 offen lds
    s_add_u32 s45, s42, 512
    s_add_u32 m0, s44, 65536
    s_nop 0
    buffer_load_dwordx4 v32, s[12:15], s45 offen lds
    s_add_u32 s45, s42, 8704
    s_add_u32 m0, s44, 66560
    s_nop 0
    buffer_load_dwordx4 v33, s[12:15], s45 offen lds
    s_add_u32 s45, s43, 262144
    s_add_u32 m0, s44, 73728
    s_nop 0
    buffer_load_dwordx4 v34, s[16:19], s45 offen lds
    s_add_u32 s45, s43, 270336
    s_add_u32 m0, s44, 74752
    s_nop 0
    buffer_load_dwordx4 v34, s[16:19], s45 offen lds
    s_add_u32 s45, s42, 640
    s_add_u32 m0, s44, 81920
    s_nop 0
    buffer_load_dwordx4 v32, s[12:15], s45 offen lds
    s_add_u32 s45, s42, 8832
    s_add_u32 m0, s44, 82944
    s_nop 0
    buffer_load_dwordx4 v33, s[12:15], s45 offen lds
    s_add_u32 s45, s43, 327680
    s_add_u32 m0, s44, 90112
    s_nop 0
    buffer_load_dwordx4 v34, s[16:19], s45 offen lds
    s_add_u32 s45, s43, 335872
    s_add_u32 m0, s44, 91136
    s_nop 0
    buffer_load_dwordx4 v34, s[16:19], s45 offen lds
    s_add_u32 s45, s42, 768
    s_add_u32 m0, s44, 98304
    s_nop 0
    buffer_load_dwordx4 v32, s[12:15], s45 offen lds
    s_add_u32 s45, s42, 8960
    s_add_u32 m0, s44, 99328
    s_nop 0
    buffer_load_dwordx4 v33, s[12:15], s45 offen lds
    s_add_u32 s45, s43, 393216
    s_add_u32 m0, s44, 106496
    s_nop 0
    buffer_load_dwordx4 v34, s[16:19], s45 offen lds
    s_add_u32 s45, s43, 401408
    s_add_u32 m0, s44, 107520
    s_nop 0
    buffer_load_dwordx4 v34, s[16:19], s45 offen lds
    s_add_u32 s45, s42, 896
    s_add_u32 m0, s44, 114688
    s_nop 0
    buffer_load_dwordx4 v32, s[12:15], s45 offen lds
    s_add_u32 s45, s42, 9088
    s_add_u32 m0, s44, 115712
    s_nop 0
    buffer_load_dwordx4 v33, s[12:15], s45 offen lds
    s_add_u32 s45, s43, 458752
    s_add_u32 m0, s44, 122880
    s_nop 0
    buffer_load_dwordx4 v34, s[16:19], s45 offen lds
    s_add_u32 s45, s43, 466944
    s_add_u32 m0, s44, 123904
    s_nop 0
    buffer_load_dwordx4 v34, s[16:19], s45 offen lds
    s_waitcnt vmcnt(28)
    s_barrier
    ds_read_b128 v[60:63], v37 offset:0
    ds_read_b64_tr_b16 v[68:69], v41 offset:0
    ds_read_b64_tr_b16 v[70:71], v41 offset:512
    ds_read_b128 v[64:67], v38 offset:0
    ds_read_b64_tr_b16 v[72:73], v41 offset:2048
    ds_read_b64_tr_b16 v[74:75], v41 offset:2560
    s_waitcnt lgkmcnt(3)
    v_mfma_f32_32x32x16_bf16 v[44:59], v[68:71], v[60:63], v[44:59]
    ds_read_b128 v[60:63], v39 offset:0
    ds_read_b64_tr_b16 v[68:69], v41 offset:4096
    ds_read_b64_tr_b16 v[70:71], v41 offset:4608
    s_waitcnt lgkmcnt(3)
    v_mfma_f32_32x32x16_bf16 v[44:59], v[72:75], v[64:67], v[44:59]
    ds_read_b128 v[64:67], v40 offset:0
    ds_read_b64_tr_b16 v[72:73], v41 offset:6144
    ds_read_b64_tr_b16 v[74:75], v41 offset:6656
    s_waitcnt lgkmcnt(3)
    v_mfma_f32_32x32x16_bf16 v[44:59], v[68:71], v[60:63], v[44:59]
    s_waitcnt lgkmcnt(0)
    v_mfma_f32_32x32x16_bf16 v[44:59], v[72:75], v[64:67], v[44:59]
    s_waitcnt vmcnt(24)
    s_barrier
    v_add_u32 v37, 16384, v37
    v_add_u32 v38, 16384, v38
    v_add_u32 v39, 16384, v39
    v_add_u32 v40, 16384, v40
    v_add_u32 v41, 16384, v41
    ds_read_b128 v[60:63], v37 offset:0
    ds_read_b64_tr_b16 v[68:69], v41 offset:0
    ds_read_b64_tr_b16 v[70:71], v41 offset:512
    ds_read_b128 v[64:67], v38 offset:0
    ds_read_b64_tr_b16 v[72:73], v41 offset:2048
    ds_read_b64_tr_b16 v[74:75], v41 offset:2560
    s_waitcnt lgkmcnt(3)
    v_mfma_f32_32x32x16_bf16 v[44:59], v[68:71], v[60:63], v[44:59]
    ds_read_b128 v[60:63], v39 offset:0
    ds_read_b64_tr_b16 v[68:69], v41 offset:4096
    ds_read_b64_tr_b16 v[70:71], v41 offset:4608
    s_waitcnt lgkmcnt(3)
    v_mfma_f32_32x32x16_bf16 v[44:59], v[72:75], v[64:67], v[44:59]
    ds_read_b128 v[64:67], v40 offset:0
    ds_read_b64_tr_b16 v[72:73], v41 offset:6144
    ds_read_b64_tr_b16 v[74:75], v41 offset:6656
    s_waitcnt lgkmcnt(3)
    v_mfma_f32_32x32x16_bf16 v[44:59], v[68:71], v[60:63], v[44:59]
    s_waitcnt lgkmcnt(0)
    v_mfma_f32_32x32x16_bf16 v[44:59], v[72:75], v[64:67], v[44:59]
    s_waitcnt vmcnt(20)
    s_barrier
    v_add_u32 v37, 16384, v37
    v_add_u32 v38, 16384, v38
    v_add_u32 v39, 16384, v39
    v_add_u32 v40, 16384, v40
    v_add_u32 v41, 16384, v41
    ds_read_b128 v[60:63], v37 offset:0
    ds_read_b64_tr_b16 v[68:69], v41 offset:0
    ds_read_b64_tr_b16 v[70:71], v41 offset:512
    ds_read_b128 v[64:67], v38 offset:0
    ds_read_b64_tr_b16 v[72:73], v41 offset:2048
    ds_read_b64_tr_b16 v[74:75], v41 offset:2560
    s_waitcnt lgkmcnt(3)
    v_mfma_f32_32x32x16_bf16 v[44:59], v[68:71], v[60:63], v[44:59]
    ds_read_b128 v[60:63], v39 offset:0
    ds_read_b64_tr_b16 v[68:69], v41 offset:4096
    ds_read_b64_tr_b16 v[70:71], v41 offset:4608
    s_waitcnt lgkmcnt(3)
    v_mfma_f32_32x32x16_bf16 v[44:59], v[72:75], v[64:67], v[44:59]
    ds_read_b128 v[64:67], v40 offset:0
    ds_read_b64_tr_b16 v[72:73], v41 offset:6144
    ds_read_b64_tr_b16 v[74:75], v41 offset:6656
    s_waitcnt lgkmcnt(3)
    v_mfma_f32_32x32x16_bf16 v[44:59], v[68:71], v[60:63], v[44:59]
    s_waitcnt lgkmcnt(0)
    v_mfma_f32_32x32x16_bf16 v[44:59], v[72:75], v[64:67], v[44:59]
    s_waitcnt vmcnt(16)
    s_barrier
    v_add_u32 v37, 16384, v37
    v_add_u32 v38, 16384, v38
    v_add_u32 v39, 16384, v39
    v_add_u32 v40, 16384, v40
    v_add_u32 v41, 16384, v41
    ds_read_b128 v[60:63], v37 offset:0
    ds_read_b64_tr_b16 v[68:69], v41 offset:0
    ds_read_b64_tr_b16 v[70:71], v41 offset:512
    ds_read_b128 v[64:67], v38 offset:0
    ds_read_b64_tr_b16 v[72:73], v41 offset:2048
    ds_read_b64_tr_b16 v[74:75], v41 offset:2560
    s_waitcnt lgkmcnt(3)
    v_mfma_f32_32x32x16_bf16 v[44:59], v[68:71], v[60:63], v[44:59]
    ds_read_b128 v[60:63], v39 offset:0
    ds_read_b64_tr_b16 v[68:69], v41 offset:4096
    ds_read_b64_tr_b16 v[70:71], v41 offset:4608
    s_waitcnt lgkmcnt(3)
    v_mfma_f32_32x32x16_bf16 v[44:59], v[72:75], v[64:67], v[44:59]
    ds_read_b128 v[64:67], v40 offset:0
    ds_read_b64_tr_b16 v[72:73], v41 offset:6144
    ds_read_b64_tr_b16 v[74:75], v41 offset:6656
    s_waitcnt lgkmcnt(3)
    v_mfma_f32_32x32x16_bf16 v[44:59], v[68:71], v[60:63], v[44:59]
    s_waitcnt lgkmcnt(0)
    v_mfma_f32_32x32x16_bf16 v[44:59], v[72:75], v[64:67], v[44:59]
    s_waitcnt vmcnt(12)
    s_barrier
    v_add_u32 v37, 16384, v37
    v_add_u32 v38, 16384, v38
    v_add_u32 v39, 16384, v39
    v_add_u32 v40, 16384, v40
    v_add_u32 v41, 16384, v41
    ds_read_b128 v[60:63], v37 offset:0
    ds_read_b64_tr_b16 v[68:69], v41 offset:0
    ds_read_b64_tr_b16 v[70:71], v41 offset:512
    ds_read_b128 v[64:67], v38 offset:0
    ds_read_b64_tr_b16 v[72:73], v41 offset:2048
    ds_read_b64_tr_b16 v[74:75], v41 offset:2560
    s_waitcnt lgkmcnt(3)
    v_mfma_f32_32x32x16_bf16 v[44:59], v[68:71], v[60:63], v[44:59]
    ds_read_b128 v[60:63], v39 offset:0
    ds_read_b64_tr_b16 v[68:69], v41 offset:4096
    ds_read_b64_tr_b16 v[70:71], v41 offset:4608
    s_waitcnt lgkmcnt(3)
    v_mfma_f32_32x32x16_bf16 v[44:59], v[72:75], v[64:67], v[44:59]
    ds_read_b128 v[64:67], v40 offset:0
    ds_read_b64_tr_b16 v[72:73], v41 offset:6144
    ds_read_b64_tr_b16 v[74:75], v41 offset:6656
    s_waitcnt lgkmcnt(3)
    v_mfma_f32_32x32x16_bf16 v[44:59], v[68:71], v[60:63], v[44:59]
    s_waitcnt lgkmcnt(0)
    v_mfma_f32_32x32x16_bf16 v[44:59], v[72:75], v[64:67], v[44:59]
    s_waitcnt vmcnt(8)
    s_barrier
    v_add_u32 v37, 16384, v37
    v_add_u32 v38, 16384, v38
    v_add_u32 v39, 16384, v39
    v_add_u32 v40, 16384, v40
    v_add_u32 v41, 16384, v41
    ds_read_b128 v[60:63], v37 offset:0
    ds_read_b64_tr_b16 v[68:69], v41 offset:0
    ds_read_b64_tr_b16 v[70:71], v41 offset:512
    ds_read_b128 v[64:67], v38 offset:0
    ds_read_b64_tr_b16 v[72:73], v41 offset:2048
    ds_read_b64_tr_b16 v[74:75], v41 offset:2560
    s_waitcnt lgkmcnt(3)
    v_mfma_f32_32x32x16_bf16 v[44:59], v[68:71], v[60:63], v[44:59]
    ds_read_b128 v[60:63], v39 offset:0
    ds_read_b64_tr_b16 v[68:69], v41 offset:4096
    ds_read_b64_tr_b16 v[70:71], v41 offset:4608
    s_waitcnt lgkmcnt(3)
    v_mfma_f32_32x32x16_bf16 v[44:59], v[72:75], v[64:67], v[44:59]
    ds_read_b128 v[64:67], v40 offset:0
    ds_read_b64_tr_b16 v[72:73], v41 offset:6144
    ds_read_b64_tr_b16 v[74:75], v41 offset:6656
    s_waitcnt lgkmcnt(3)
    v_mfma_f32_32x32x16_bf16 v[44:59], v[68:71], v[60:63], v[44:59]
    s_waitcnt lgkmcnt(0)
    v_mfma_f32_32x32x16_bf16 v[44:59], v[72:75], v[64:67], v[44:59]
    s_waitcnt vmcnt(4)
    s_barrier
    v_add_u32 v37, 16384, v37
    v_add_u32 v38, 16384, v38
    v_add_u32 v39, 16384, v39
    v_add_u32 v40, 16384, v40
    v_add_u32 v41, 16384, v41
    ds_read_b128 v[60:63], v37 offset:0
    ds_read_b64_tr_b16 v[68:69], v41 offset:0
    ds_read_b64_tr_b16 v[70:71], v41 offset:512
    ds_read_b128 v[64:67], v38 offset:0
    ds_read_b64_tr_b16 v[72:73], v41 offset:2048
    ds_read_b64_tr_b16 v[74:75], v41 offset:2560
    s_waitcnt lgkmcnt(3)
    v_mfma_f32_32x32x16_bf16 v[44:59], v[68:71], v[60:63], v[44:59]
    ds_read_b128 v[60:63], v39 offset:0
    ds_read_b64_tr_b16 v[68:69], v41 offset:4096
    ds_read_b64_tr_b16 v[70:71], v41 offset:4608
    s_waitcnt lgkmcnt(3)
    v_mfma_f32_32x32x16_bf16 v[44:59], v[72:75], v[64:67], v[44:59]
    ds_read_b128 v[64:67], v40 offset:0
    ds_read_b64_tr_b16 v[72:73], v41 offset:6144
    ds_read_b64_tr_b16 v[74:75], v41 offset:6656
    s_waitcnt lgkmcnt(3)
    v_mfma_f32_32x32x16_bf16 v[44:59], v[68:71], v[60:63], v[44:59]
    s_waitcnt lgkmcnt(0)
    v_mfma_f32_32x32x16_bf16 v[44:59], v[72:75], v[64:67], v[44:59]
    s_waitcnt vmcnt(0)
    s_barrier
    v_add_u32 v37, 16384, v37
    v_add_u32 v38, 16384, v38
    v_add_u32 v39, 16384, v39
    v_add_u32 v40, 16384, v40
    v_add_u32 v41, 16384, v41
    ds_read_b128 v[60:63], v37 offset:0
    ds_read_b64_tr_b16 v[68:69], v41 offset:0
    ds_read_b64_tr_b16 v[70:71], v41 offset:512
    ds_read_b128 v[64:67], v38 offset:0
    ds_read_b64_tr_b16 v[72:73], v41 offset:2048
    ds_read_b64_tr_b16 v[74:75], v41 offset:2560
    s_waitcnt lgkmcnt(3)
    v_mfma_f32_32x32x16_bf16 v[44:59], v[68:71], v[60:63], v[44:59]
    ds_read_b128 v[60:63], v39 offset:0
    ds_read_b64_tr_b16 v[68:69], v41 offset:4096
    ds_read_b64_tr_b16 v[70:71], v41 offset:4608
    s_waitcnt lgkmcnt(3)
    v_mfma_f32_32x32x16_bf16 v[44:59], v[72:75], v[64:67], v[44:59]
    ds_read_b128 v[64:67], v40 offset:0
    ds_read_b64_tr_b16 v[72:73], v41 offset:6144
    ds_read_b64_tr_b16 v[74:75], v41 offset:6656
    s_waitcnt lgkmcnt(3)
    v_mfma_f32_32x32x16_bf16 v[44:59], v[68:71], v[60:63], v[44:59]
    s_waitcnt lgkmcnt(0)
    v_mfma_f32_32x32x16_bf16 v[44:59], v[72:75], v[64:67], v[44:59]
    v_sub_f32 v32, 1.0, v7
    v_cvt_pk_bf16_f32 v33, v32, v32
    v_lshlrev_b32 v32, 16, v33
    s_nop 8
    v_cvt_pk_bf16_f32 v33, v44, v45
    v_lshlrev_b32 v44, 16, v33
    v_and_b32 v45, 0xffff0000, v33
    v_cvt_pk_bf16_f32 v33, v46, v47
    v_lshlrev_b32 v46, 16, v33
    v_and_b32 v47, 0xffff0000, v33
    v_lshlrev_b32 v34, 16, v8
    v_lshlrev_b32 v16, 16, v16
    v_mul_f32 v34, v34, v16
    v_and_b32 v35, 0xffff0000, v8
    v_lshlrev_b32 v17, 16, v17
    v_mul_f32 v35, v35, v17
    v_lshlrev_b32 v36, 16, v9
    v_lshlrev_b32 v18, 16, v18
    v_mul_f32 v36, v36, v18
    v_and_b32 v37, 0xffff0000, v9
    v_lshlrev_b32 v19, 16, v19
    v_mul_f32 v37, v37, v19
    v_cvt_pk_bf16_f32 v33, v34, v35
    v_lshlrev_b32 v34, 16, v33
    v_and_b32 v35, 0xffff0000, v33
    v_cvt_pk_bf16_f32 v33, v36, v37
    v_lshlrev_b32 v36, 16, v33
    v_and_b32 v37, 0xffff0000, v33
    v_mul_f32 v34, v7, v34
    v_mul_f32 v44, v32, v44
    v_mul_f32 v35, v7, v35
    v_mul_f32 v45, v32, v45
    v_mul_f32 v36, v7, v36
    v_mul_f32 v46, v32, v46
    v_mul_f32 v37, v7, v37
    v_mul_f32 v47, v32, v47
    v_cvt_pk_bf16_f32 v33, v34, v35
    v_lshlrev_b32 v34, 16, v33
    v_and_b32 v35, 0xffff0000, v33
    v_cvt_pk_bf16_f32 v33, v36, v37
    v_lshlrev_b32 v36, 16, v33
    v_and_b32 v37, 0xffff0000, v33
    v_cvt_pk_bf16_f32 v33, v44, v45
    v_lshlrev_b32 v44, 16, v33
    v_and_b32 v45, 0xffff0000, v33
    v_cvt_pk_bf16_f32 v33, v46, v47
    v_lshlrev_b32 v46, 16, v33
    v_and_b32 v47, 0xffff0000, v33
    v_add_f32 v44, v44, v34
    v_add_f32 v45, v45, v35
    v_add_f32 v46, v46, v36
    v_add_f32 v47, v47, v37
    v_cvt_pk_bf16_f32 v38, v44, v45
    v_cvt_pk_bf16_f32 v39, v46, v47
    buffer_store_dwordx2 v[38:39], v4, s[24:27], s37 offen offset:0
    v_cvt_pk_bf16_f32 v33, v48, v49
    v_lshlrev_b32 v48, 16, v33
    v_and_b32 v49, 0xffff0000, v33
    v_cvt_pk_bf16_f32 v33, v50, v51
    v_lshlrev_b32 v50, 16, v33
    v_and_b32 v51, 0xffff0000, v33
    v_lshlrev_b32 v34, 16, v10
    v_lshlrev_b32 v20, 16, v20
    v_mul_f32 v34, v34, v20
    v_and_b32 v35, 0xffff0000, v10
    v_lshlrev_b32 v21, 16, v21
    v_mul_f32 v35, v35, v21
    v_lshlrev_b32 v36, 16, v11
    v_lshlrev_b32 v22, 16, v22
    v_mul_f32 v36, v36, v22
    v_and_b32 v37, 0xffff0000, v11
    v_lshlrev_b32 v23, 16, v23
    v_mul_f32 v37, v37, v23
    v_cvt_pk_bf16_f32 v33, v34, v35
    v_lshlrev_b32 v34, 16, v33
    v_and_b32 v35, 0xffff0000, v33
    v_cvt_pk_bf16_f32 v33, v36, v37
    v_lshlrev_b32 v36, 16, v33
    v_and_b32 v37, 0xffff0000, v33
    v_mul_f32 v34, v7, v34
    v_mul_f32 v48, v32, v48
    v_mul_f32 v35, v7, v35
    v_mul_f32 v49, v32, v49
    v_mul_f32 v36, v7, v36
    v_mul_f32 v50, v32, v50
    v_mul_f32 v37, v7, v37
    v_mul_f32 v51, v32, v51
    v_cvt_pk_bf16_f32 v33, v34, v35
    v_lshlrev_b32 v34, 16, v33
    v_and_b32 v35, 0xffff0000, v33
    v_cvt_pk_bf16_f32 v33, v36, v37
    v_lshlrev_b32 v36, 16, v33
    v_and_b32 v37, 0xffff0000, v33
    v_cvt_pk_bf16_f32 v33, v48, v49
    v_lshlrev_b32 v48, 16, v33
    v_and_b32 v49, 0xffff0000, v33
    v_cvt_pk_bf16_f32 v33, v50, v51
    v_lshlrev_b32 v50, 16, v33
    v_and_b32 v51, 0xffff0000, v33
    v_add_f32 v48, v48, v34
    v_add_f32 v49, v49, v35
    v_add_f32 v50, v50, v36
    v_add_f32 v51, v51, v37
    v_cvt_pk_bf16_f32 v38, v48, v49
    v_cvt_pk_bf16_f32 v39, v50, v51
    buffer_store_dwordx2 v[38:39], v4, s[24:27], s37 offen offset:16
    v_cvt_pk_bf16_f32 v33, v52, v53
    v_lshlrev_b32 v52, 16, v33
    v_and_b32 v53, 0xffff0000, v33
    v_cvt_pk_bf16_f32 v33, v54, v55
    v_lshlrev_b32 v54, 16, v33
    v_and_b32 v55, 0xffff0000, v33
    v_lshlrev_b32 v34, 16, v12
    v_lshlrev_b32 v24, 16, v24
    v_mul_f32 v34, v34, v24
    v_and_b32 v35, 0xffff0000, v12
    v_lshlrev_b32 v25, 16, v25
    v_mul_f32 v35, v35, v25
    v_lshlrev_b32 v36, 16, v13
    v_lshlrev_b32 v26, 16, v26
    v_mul_f32 v36, v36, v26
    v_and_b32 v37, 0xffff0000, v13
    v_lshlrev_b32 v27, 16, v27
    v_mul_f32 v37, v37, v27
    v_cvt_pk_bf16_f32 v33, v34, v35
    v_lshlrev_b32 v34, 16, v33
    v_and_b32 v35, 0xffff0000, v33
    v_cvt_pk_bf16_f32 v33, v36, v37
    v_lshlrev_b32 v36, 16, v33
    v_and_b32 v37, 0xffff0000, v33
    v_mul_f32 v34, v7, v34
    v_mul_f32 v52, v32, v52
    v_mul_f32 v35, v7, v35
    v_mul_f32 v53, v32, v53
    v_mul_f32 v36, v7, v36
    v_mul_f32 v54, v32, v54
    v_mul_f32 v37, v7, v37
    v_mul_f32 v55, v32, v55
    v_cvt_pk_bf16_f32 v33, v34, v35
    v_lshlrev_b32 v34, 16, v33
    v_and_b32 v35, 0xffff0000, v33
    v_cvt_pk_bf16_f32 v33, v36, v37
    v_lshlrev_b32 v36, 16, v33
    v_and_b32 v37, 0xffff0000, v33
    v_cvt_pk_bf16_f32 v33, v52, v53
    v_lshlrev_b32 v52, 16, v33
    v_and_b32 v53, 0xffff0000, v33
    v_cvt_pk_bf16_f32 v33, v54, v55
    v_lshlrev_b32 v54, 16, v33
    v_and_b32 v55, 0xffff0000, v33
    v_add_f32 v52, v52, v34
    v_add_f32 v53, v53, v35
    v_add_f32 v54, v54, v36
    v_add_f32 v55, v55, v37
    v_cvt_pk_bf16_f32 v38, v52, v53
    v_cvt_pk_bf16_f32 v39, v54, v55
    buffer_store_dwordx2 v[38:39], v4, s[24:27], s37 offen offset:32
    v_cvt_pk_bf16_f32 v33, v56, v57
    v_lshlrev_b32 v56, 16, v33
    v_and_b32 v57, 0xffff0000, v33
    v_cvt_pk_bf16_f32 v33, v58, v59
    v_lshlrev_b32 v58, 16, v33
    v_and_b32 v59, 0xffff0000, v33
    v_lshlrev_b32 v34, 16, v14
    v_lshlrev_b32 v28, 16, v28
    v_mul_f32 v34, v34, v28
    v_and_b32 v35, 0xffff0000, v14
    v_lshlrev_b32 v29, 16, v29
    v_mul_f32 v35, v35, v29
    v_lshlrev_b32 v36, 16, v15
    v_lshlrev_b32 v30, 16, v30
    v_mul_f32 v36, v36, v30
    v_and_b32 v37, 0xffff0000, v15
    v_lshlrev_b32 v31, 16, v31
    v_mul_f32 v37, v37, v31
    v_cvt_pk_bf16_f32 v33, v34, v35
    v_lshlrev_b32 v34, 16, v33
    v_and_b32 v35, 0xffff0000, v33
    v_cvt_pk_bf16_f32 v33, v36, v37
    v_lshlrev_b32 v36, 16, v33
    v_and_b32 v37, 0xffff0000, v33
    v_mul_f32 v34, v7, v34
    v_mul_f32 v56, v32, v56
    v_mul_f32 v35, v7, v35
    v_mul_f32 v57, v32, v57
    v_mul_f32 v36, v7, v36
    v_mul_f32 v58, v32, v58
    v_mul_f32 v37, v7, v37
    v_mul_f32 v59, v32, v59
    v_cvt_pk_bf16_f32 v33, v34, v35
    v_lshlrev_b32 v34, 16, v33
    v_and_b32 v35, 0xffff0000, v33
    v_cvt_pk_bf16_f32 v33, v36, v37
    v_lshlrev_b32 v36, 16, v33
    v_and_b32 v37, 0xffff0000, v33
    v_cvt_pk_bf16_f32 v33, v56, v57
    v_lshlrev_b32 v56, 16, v33
    v_and_b32 v57, 0xffff0000, v33
    v_cvt_pk_bf16_f32 v33, v58, v59
    v_lshlrev_b32 v58, 16, v33
    v_and_b32 v59, 0xffff0000, v33
    v_add_f32 v56, v56, v34
    v_add_f32 v57, v57, v35
    v_add_f32 v58, v58, v36
    v_add_f32 v59, v59, v37
    v_cvt_pk_bf16_f32 v38, v56, v57
    v_cvt_pk_bf16_f32 v39, v58, v59
    buffer_store_dwordx2 v[38:39], v4, s[24:27], s37 offen offset:48
k3_outproj_mix_kernel_end1:
    s_endpgm
.section .rodata,"a"
.p2align 6
.amdhsa_kernel k3_outproj_mix_kernel
  .amdhsa_next_free_vgpr 76
  .amdhsa_next_free_sgpr 46
  .amdhsa_accum_offset 76
  .amdhsa_group_segment_fixed_size 0
  .amdhsa_kernarg_size 104
  .amdhsa_user_sgpr_count 2
  .amdhsa_user_sgpr_kernarg_segment_ptr 1
  .amdhsa_system_sgpr_workgroup_id_x 1
  .amdhsa_float_denorm_mode_32 3
  .amdhsa_float_denorm_mode_16_64 3
.end_amdhsa_kernel
.text
```
